```python
import torch

def _softmax(x, axis=-1):
    return torch.softmax(x, dim=axis)
def _gelu(x):
    return torch.nn.functional.gelu(x, approximate="tanh")
def _silu(x):
    return torch.nn.functional.silu(x)
def _sigmoid(x):
    return torch.sigmoid(x)
def _layernorm(x, axis=-1, eps=1e-5):
    m = x.mean(dim=axis, keepdim=True)
    v = x.var(dim=axis, keepdim=True, unbiased=False)
    return (x - m) / torch.sqrt(v + eps)
def _scatter_add(tgt, idx, src, axis=0):
    return tgt.clone().index_add_(axis, idx, src)
def _segment_sum(src, seg, n):
    out = torch.zeros((n,) + src.shape[1:], dtype=src.dtype)
    return out.index_add_(0, seg, src)
def _pad(x, pw):
    flat = tuple(v for pair in reversed(pw) for v in pair)
    return torch.nn.functional.pad(x, flat)

kernel_name = 'sequential_preLN__ssm_conv_h3__glu_gated_geglu__prompt'

def setup_inputs():

    _w = (lambda a: (lambda t: t.to(torch.bfloat16) if t.is_floating_point() else t)(torch.as_tensor(a)))
    def _A_setup():
        B, S, D = 1, 2048, 576
        ks = 4
        return {
            "q": _w((lambda *s: torch.randn(*s, dtype=torch.bfloat16) * 0.05)(B, S, D)),
            "k": _w((lambda *s: torch.randn(*s, dtype=torch.bfloat16) * 0.2)(B, S, D)),
            "v": _w((lambda *s: torch.randn(*s, dtype=torch.bfloat16) * 0.2)(B, S, D)),
            "shift_k": _w((lambda *s: torch.randn(*s, dtype=torch.bfloat16) * 0.2)(D, ks) * 0.5),
            "ssm_k": _w((lambda *s: torch.randn(*s, dtype=torch.bfloat16) * 0.4)(D, S) * (1.0 / S ** 0.5)),
            "ssm_D": _w((lambda *s: torch.randn(*s, dtype=torch.bfloat16) * 0.2)(D)),
        }
    _A_in = _A_setup()

    def _B_setup():
        B, S, Dm, Df = 1, 2048, 576, 4608
        return {
            "x": _w((lambda *s: torch.randn(*s, dtype=torch.bfloat16) * 0.05)(B, S, Dm)),
            "w_gate": _w((lambda *s: torch.randn(*s, dtype=torch.bfloat16) * 0.4)(Dm, Df) * (Dm ** -0.5)),
            "w_up": _w((lambda *s: torch.randn(*s, dtype=torch.bfloat16) * 0.4)(Dm, Df) * (Dm ** -0.5)),
            "w_down": _w((lambda *s: torch.randn(*s, dtype=torch.bfloat16) * 0.4)(Df, Dm) * (Df ** -0.5)),
        }
    _B_in = _B_setup()

    return {
        "A_q": _A_in["q"],
        "A_k": _A_in["k"],
        "A_v": _A_in["v"],
        "A_shift_k": _A_in["shift_k"],
        "A_ssm_k": _A_in["ssm_k"],
        "A_ssm_D": _A_in["ssm_D"],
        "B_x": _B_in["x"],
        "B_w_gate": _B_in["w_gate"],
        "B_w_up": _B_in["w_up"],
        "B_w_down": _B_in["w_down"],
    }

def reference(A_q, A_k, A_v, A_shift_k, A_ssm_k, A_ssm_D, B_x, B_w_gate, B_w_up, B_w_down):
    def _A_ref(q, k, v, shift_k, ssm_k, ssm_D):
        B, S, D = q.shape
        ks = shift_k.shape[-1]
        k_pad = _pad(k, ((0, 0), (ks - 1, 0), (0, 0)))
        k_shift = torch.zeros_like(k)
        for t in range(ks):
            k_shift = k_shift + k_pad[:, t:t + S, :] * shift_k[:, ks - 1 - t][None, None, :]
        kv = k_shift * v
        L = 2 * S
        kv_pad = _pad(kv, ((0, 0), (0, S), (0, 0)))
        kf_pad = _pad(ssm_k, ((0, 0), (0, S)))
        kv_f = (lambda x, axes=(-2,-1): torch.fft.rfft2(x.float(), dim=axes))(kv_pad[:, None, :, :], axes=(1, 2))
        kf_f = (lambda x, axes=(-2,-1): torch.fft.rfft2(x.float(), dim=axes))(kf_pad[:, None, :], axes=(1, 2))
        kf_f = (lambda x, *d: x.permute(*d))(kf_f, 1, 2, 0)
        y_f = kv_f * kf_f[None, :, :, :]
        y = (lambda x, s, axes=(-2,-1): torch.fft.irfft2(x, s=s, dim=axes).to(torch.bfloat16))(y_f, (1, L), axes=(1, 2))[:, 0, :S, :]
        y = y + kv * ssm_D[None, None, :]
        return q * y

    def _B_ref(x, w_gate, w_up, w_down):
        g = torch.einsum("bsd,df->bsf", x, w_gate)
        u = torch.einsum("bsd,df->bsf", x, w_up)
        h = _gelu(g) * u
        return torch.einsum("bsf,fd->bsd", h, w_down)

    x = A_q
    h = x + _A_ref(_layernorm(x, axis=-1), A_k, A_v, A_shift_k, A_ssm_k, A_ssm_D)
    h2 = h + _B_ref(_layernorm(h, axis=-1), B_w_gate, B_w_up, B_w_down)
    return h2
```

```asm
; @launch kernel=ka_kernel grid=(256,1,1) block=(512,1,1) lds=147456
; @launch kernel=kc_kernel grid=(256,1,1) block=(512,1,1) lds=157696
.amdgcn_target "amdgcn-amd-amdhsa--gfx950"
.text
.globl ka_kernel
.p2align 8
.type ka_kernel,@function
ka_kernel:
    s_cmp_ge_u32 s2, 256
    s_cbranch_scc1 ka_done
    s_load_dwordx2 s[26:27], s[0:1], 96
    s_load_dwordx2 s[50:51], s[0:1], 88
    s_load_dwordx2 s[38:39], s[0:1], 0
    s_cmp_ge_u32 s2, 144
    s_cbranch_scc1 ka_stats
    s_load_dwordx4 s[4:7], s[0:1], 8
    s_load_dwordx2 s[24:25], s[0:1], 24
    s_load_dwordx4 s[64:67], s[0:1], 32
    v_lshrrev_b32 v1, 6, v0
    v_and_b32 v100, 63, v0
    v_and_b32 v101, 255, v0
    v_readfirstlane_b32 s60, v1
    s_lshr_b32 s29, s2, 4
    s_and_b32 s28, s2, 15
    s_lshr_b32 s61, s60, 2
    s_and_b32 s62, s60, 3
    s_lshl_b32 s28, s28, 1
    s_add_u32 s28, s28, s61
    s_lshl_b32 s30, s28, 6
    v_lshrrev_b32 v1, 3, v101
    v_and_b32 v2, 7, v101
    v_lshlrev_b32 v3, 1, v1
    v_add_u32 v3, s30, v3
    s_movk_i32 s31, 1152
    v_mul_lo_u32 v4, v3, s31
    s_lshl_b32 s32, s29, 7
    v_lshlrev_b32 v5, 4, v2
    v_add3_u32 v4, v4, v5, s32

    s_lshl_b32 s63, s2, 2
    s_add_u32 s63, s63, s62
    s_mul_i32 s68, s62, 25920
    s_lshl_b32 s31, s63, 12
    v_lshlrev_b32 v102, 4, v100
    v_lshrrev_b32 v6, 3, v100
    v_mul_u32_u24 v6, 1152, v6
    v_and_b32 v7, 7, v100
    v_lshl_add_u32 v6, v7, 4, v6
    s_and_b32 s33, s2, 15
    s_mul_i32 s33, s33, 147456
    s_add_u32 s33, s33, s32
    s_mul_i32 s34, s60, 18432
    s_add_u32 s34, s34, s33
    s_add_u32 s35, s34, 9216
    s_lshl_b32 s36, s60, 11
    s_sub_u32 s37, s33, 9216
    s_cmp_lt_u32 s33, 9216
    s_cselect_b32 s37, 0x7ffffff0, s37
    s_waitcnt lgkmcnt(0)

    s_mov_b32 s8, s4
    s_mov_b32 s9, s5
    s_mov_b32 s10, 0x240000
    s_mov_b32 s11, 0x00020000
    s_mov_b32 s12, s6
    s_mov_b32 s13, s7
    s_mov_b32 s14, 0x240000
    s_mov_b32 s15, 0x00020000
    s_mov_b32 s16, s24
    s_mov_b32 s17, s25
    s_mov_b32 s18, 0x1200
    s_mov_b32 s19, 0x00020000
    s_mov_b32 s40, s38
    s_mov_b32 s41, s39
    s_mov_b32 s42, 0x240000
    s_mov_b32 s43, 0x00020000
    s_add_u32 m0, s36, 1024
    s_nop 0
    buffer_load_dwordx4 v6, s[8:11], s34 offen lds
    s_add_u32 m0, s36, 2048
    s_nop 0
    buffer_load_dwordx4 v6, s[8:11], s35 offen lds
    s_add_u32 m0, s36, 18432
    s_nop 0
    buffer_load_dwordx4 v6, s[12:15], s34 offen lds
    s_add_u32 m0, s36, 19456
    s_nop 0
    buffer_load_dwordx4 v6, s[12:15], s35 offen lds
    s_cmp_lg_u32 s60, 0
    s_cbranch_scc1 ka_h1
    s_mov_b32 m0, 0
    s_nop 0
    buffer_load_dwordx4 v6, s[8:11], s37 offen lds

ka_h1:
    s_cmp_lg_u32 s60, 1
    s_cbranch_scc1 ka_h2
    s_mov_b32 m0, 17408
    s_nop 0
    buffer_load_dwordx4 v6, s[12:15], s37 offen lds

ka_h2:
    s_cmp_lg_u32 s60, 2
    s_cbranch_scc1 ka_h3
    s_mov_b32 m0, 34816
    s_lshl_b32 s33, s29, 9
    buffer_load_dwordx4 v102, s[16:19], s33 offen lds

ka_h3:
    buffer_load_dwordx4 v[92:95], v4, s[40:43], 0 offen
    buffer_load_dwordx4 v[96:99], v4, s[40:43], 0 offen offset:1152
    v_lshrrev_b32 v10, 3, v0
    v_lshlrev_b32 v10, 8, v10
    v_add_u32 v10, v10, v5
    v_lshlrev_b32 v11, 6, v2

    s_add_u32 s56, s26, 0x3eae000
    s_addc_u32 s57, s27, 0
    s_mov_b32 s58, 0x4800
    s_mov_b32 s59, 0x00020000
    s_lshl_b32 s71, s2, 7
    v_lshlrev_b32 v106, 2, v100
    v_mov_b32 v68, 0
    v_cmp_gt_u32 vcc, 16, v0
    s_and_saveexec_b64 s[48:49], vcc
    s_cbranch_execz ka_nc
    buffer_store_dword v68, v106, s[56:59], s71 offen sc1

ka_nc:
    s_mov_b64 exec, s[48:49]
    s_add_u32 s20, s26, 0x0
    s_addc_u32 s21, s27, 0
    s_mov_b32 s22, 0x480000
    s_mov_b32 s23, 0x00020000
    s_add_u32 s44, s26, 0x6c0000
    s_addc_u32 s45, s27, 0
    s_mov_b32 s46, 0x240000
    s_mov_b32 s47, 0x00020000
    s_mov_b32 s52, s50
    s_mov_b32 s53, s51
    s_mov_b32 s54, 0x100
    s_mov_b32 s55, 0x00020000
    s_lshr_b32 s34, s63, 1
    s_lshl_b32 s34, s34, 2
    s_add_u32 s66, s66, s34
    s_addc_u32 s67, s67, 0
    s_load_dword s69, s[66:67], 0
    s_lshl_b32 s35, s29, 18
    v_lshlrev_b32 v9, 15, v2
    v_lshl_add_u32 v9, v3, 3, v9
    v_add_u32 v9, s35, v9
    s_movk_i32 s36, 0x4000
    v_sub_u32 v7, 31, v1
    v_lshlrev_b32 v8, 2, v2
    v_xor_b32 v7, v7, v8
    v_lshlrev_b32 v7, 2, v7
    v_lshl_add_u32 v7, v2, 10, v7
    s_lshl_b32 s70, s61, 14
    s_add_u32 s70, s70, 103680
    v_add_u32 v7, s70, v7
    s_mov_b32 s34, 0xffff0000

    s_waitcnt vmcnt(0)
    s_barrier
    ds_read_b128 v[16:19], v10 offset:512
    ds_read_b128 v[20:23], v10 offset:640
    ds_read_b128 v[24:27], v10 offset:768
    ds_read_b128 v[28:31], v10 offset:896
    ds_read_b128 v[32:35], v10 offset:1024
    ds_read_b128 v[36:39], v10 offset:1152
    ds_read_b128 v[40:43], v10 offset:18304
    ds_read_b128 v[44:47], v10 offset:18432
    ds_read_b128 v[48:51], v10 offset:18560
    ds_read_b128 v[52:55], v11 offset:34816
    ds_read_b128 v[56:59], v11 offset:34832
    ds_read_b128 v[60:63], v11 offset:34848
    ds_read_b128 v[64:67], v11 offset:34864
    s_add_u32 s8, s64, s31
    s_addc_u32 s9, s65, 0
    s_mov_b32 s10, 0x1000
    s_mov_b32 s11, 0x00020000
    s_lshl_b32 s24, s61, 11
    s_add_u32 s25, s68, s24
    v_lshrrev_b32 v103, 4, v100
    v_and_b32 v104, 15, v100
    v_add_u32 v6, v103, v104
    v_add_u32 v6, -15, v6
    v_lshlrev_b32 v6, 2, v6
    buffer_load_dword v105, v6, s[8:11], 0 offen

    v_lshlrev_b32 v6, 6, v100
    buffer_load_dword v107, v6, s[8:11], 0 offen
    v_swap_b32 v94, v96
    v_swap_b32 v95, v97
    buffer_store_dwordx4 v[92:95], v9, s[44:47], 0 offen sc1
    buffer_store_dwordx4 v[96:99], v9, s[44:47], s36 offen sc1
    s_waitcnt lgkmcnt(0)

    v_lshlrev_b32 v112, 16, v16
    v_and_b32 v113, s34, v16
    v_lshlrev_b32 v114, 16, v20
    v_and_b32 v115, s34, v20
    v_lshlrev_b32 v116, 16, v24
    v_and_b32 v117, s34, v24
    v_lshlrev_b32 v118, 16, v28
    v_and_b32 v119, s34, v28
    v_lshlrev_b32 v120, 16, v32
    v_and_b32 v121, s34, v32
    v_lshlrev_b32 v122, 16, v36
    v_and_b32 v123, s34, v36
    v_lshlrev_b32 v124, 16, v40
    v_and_b32 v125, s34, v40
    v_lshlrev_b32 v126, 16, v44
    v_and_b32 v127, s34, v44
    v_lshlrev_b32 v128, 16, v48
    v_and_b32 v129, s34, v48
    v_lshlrev_b32 v130, 16, v52
    v_and_b32 v132, s34, v52
    v_lshlrev_b32 v134, 16, v53
    v_and_b32 v136, s34, v53
    v_lshlrev_b32 v131, 16, v54
    v_and_b32 v133, s34, v54
    v_lshlrev_b32 v135, 16, v55
    v_and_b32 v137, s34, v55
    v_pk_mul_f32 v[138:139], v[112:113], v[136:137]
    v_pk_mul_f32 v[140:141], v[114:115], v[136:137]
    v_pk_mul_f32 v[142:143], v[116:117], v[136:137]
    v_pk_fma_f32 v[138:139], v[114:115], v[134:135], v[138:139]
    v_pk_fma_f32 v[140:141], v[116:117], v[134:135], v[140:141]
    v_pk_fma_f32 v[142:143], v[118:119], v[134:135], v[142:143]
    v_pk_fma_f32 v[138:139], v[116:117], v[132:133], v[138:139]
    v_pk_fma_f32 v[140:141], v[118:119], v[132:133], v[140:141]
    v_pk_fma_f32 v[142:143], v[120:121], v[132:133], v[142:143]
    v_pk_fma_f32 v[138:139], v[118:119], v[130:131], v[138:139]
    v_pk_fma_f32 v[140:141], v[120:121], v[130:131], v[140:141]
    v_pk_fma_f32 v[142:143], v[122:123], v[130:131], v[142:143]
    v_pk_mul_f32 v[138:139], v[138:139], v[124:125]
    v_pk_mul_f32 v[140:141], v[140:141], v[126:127]
    v_pk_mul_f32 v[142:143], v[142:143], v[128:129]
    v_cvt_pk_bf16_f32 v88, v140, v138
    v_cvt_pk_bf16_f32 v89, v142, v140
    ds_write_b32 v7, v88 offset:0
    ds_write_b32 v7, v89 offset:8192
    v_cvt_pk_bf16_f32 v90, v141, v139
    v_cvt_pk_bf16_f32 v91, v143, v141
    ds_write_b32 v7, v90 offset:128
    ds_write_b32 v7, v91 offset:8320
    v_lshlrev_b32 v112, 16, v17
    v_and_b32 v113, s34, v17
    v_lshlrev_b32 v114, 16, v21
    v_and_b32 v115, s34, v21
    v_lshlrev_b32 v116, 16, v25
    v_and_b32 v117, s34, v25
    v_lshlrev_b32 v118, 16, v29
    v_and_b32 v119, s34, v29
    v_lshlrev_b32 v120, 16, v33
    v_and_b32 v121, s34, v33
    v_lshlrev_b32 v122, 16, v37
    v_and_b32 v123, s34, v37
    v_lshlrev_b32 v124, 16, v41
    v_and_b32 v125, s34, v41
    v_lshlrev_b32 v126, 16, v45
    v_and_b32 v127, s34, v45
    v_lshlrev_b32 v128, 16, v49
    v_and_b32 v129, s34, v49
    v_lshlrev_b32 v130, 16, v56
    v_and_b32 v132, s34, v56
    v_lshlrev_b32 v134, 16, v57
    v_and_b32 v136, s34, v57
    v_lshlrev_b32 v131, 16, v58
    v_and_b32 v133, s34, v58
    v_lshlrev_b32 v135, 16, v59
    v_and_b32 v137, s34, v59
    v_pk_mul_f32 v[138:139], v[112:113], v[136:137]
    v_pk_mul_f32 v[140:141], v[114:115], v[136:137]
    v_pk_mul_f32 v[142:143], v[116:117], v[136:137]
    v_pk_fma_f32 v[138:139], v[114:115], v[134:135], v[138:139]
    v_pk_fma_f32 v[140:141], v[116:117], v[134:135], v[140:141]
    v_pk_fma_f32 v[142:143], v[118:119], v[134:135], v[142:143]
    v_pk_fma_f32 v[138:139], v[116:117], v[132:133], v[138:139]
    v_pk_fma_f32 v[140:141], v[118:119], v[132:133], v[140:141]
    v_pk_fma_f32 v[142:143], v[120:121], v[132:133], v[142:143]
    v_pk_fma_f32 v[138:139], v[118:119], v[130:131], v[138:139]
    v_pk_fma_f32 v[140:141], v[120:121], v[130:131], v[140:141]
    v_pk_fma_f32 v[142:143], v[122:123], v[130:131], v[142:143]
    v_pk_mul_f32 v[138:139], v[138:139], v[124:125]
    v_pk_mul_f32 v[140:141], v[140:141], v[126:127]
    v_pk_mul_f32 v[142:143], v[142:143], v[128:129]
    v_cvt_pk_bf16_f32 v88, v140, v138
    v_cvt_pk_bf16_f32 v89, v142, v140
    ds_write_b32 v7, v88 offset:256
    ds_write_b32 v7, v89 offset:8448
    v_cvt_pk_bf16_f32 v90, v141, v139
    v_cvt_pk_bf16_f32 v91, v143, v141
    ds_write_b32 v7, v90 offset:384
    ds_write_b32 v7, v91 offset:8576
    v_lshlrev_b32 v112, 16, v18
    v_and_b32 v113, s34, v18
    v_lshlrev_b32 v114, 16, v22
    v_and_b32 v115, s34, v22
    v_lshlrev_b32 v116, 16, v26
    v_and_b32 v117, s34, v26
    v_lshlrev_b32 v118, 16, v30
    v_and_b32 v119, s34, v30
    v_lshlrev_b32 v120, 16, v34
    v_and_b32 v121, s34, v34
    v_lshlrev_b32 v122, 16, v38
    v_and_b32 v123, s34, v38
    v_lshlrev_b32 v124, 16, v42
    v_and_b32 v125, s34, v42
    v_lshlrev_b32 v126, 16, v46
    v_and_b32 v127, s34, v46
    v_lshlrev_b32 v128, 16, v50
    v_and_b32 v129, s34, v50
    v_lshlrev_b32 v130, 16, v60
    v_and_b32 v132, s34, v60
    v_lshlrev_b32 v134, 16, v61
    v_and_b32 v136, s34, v61
    v_lshlrev_b32 v131, 16, v62
    v_and_b32 v133, s34, v62
    v_lshlrev_b32 v135, 16, v63
    v_and_b32 v137, s34, v63
    v_pk_mul_f32 v[138:139], v[112:113], v[136:137]
    v_pk_mul_f32 v[140:141], v[114:115], v[136:137]
    v_pk_mul_f32 v[142:143], v[116:117], v[136:137]
    v_pk_fma_f32 v[138:139], v[114:115], v[134:135], v[138:139]
    v_pk_fma_f32 v[140:141], v[116:117], v[134:135], v[140:141]
    v_pk_fma_f32 v[142:143], v[118:119], v[134:135], v[142:143]
    v_pk_fma_f32 v[138:139], v[116:117], v[132:133], v[138:139]
    v_pk_fma_f32 v[140:141], v[118:119], v[132:133], v[140:141]
    v_pk_fma_f32 v[142:143], v[120:121], v[132:133], v[142:143]
    v_pk_fma_f32 v[138:139], v[118:119], v[130:131], v[138:139]
    v_pk_fma_f32 v[140:141], v[120:121], v[130:131], v[140:141]
    v_pk_fma_f32 v[142:143], v[122:123], v[130:131], v[142:143]
    v_pk_mul_f32 v[138:139], v[138:139], v[124:125]
    v_pk_mul_f32 v[140:141], v[140:141], v[126:127]
    v_pk_mul_f32 v[142:143], v[142:143], v[128:129]
    v_cvt_pk_bf16_f32 v88, v140, v138
    v_cvt_pk_bf16_f32 v89, v142, v140
    ds_write_b32 v7, v88 offset:512
    ds_write_b32 v7, v89 offset:8704
    v_cvt_pk_bf16_f32 v90, v141, v139
    v_cvt_pk_bf16_f32 v91, v143, v141
    ds_write_b32 v7, v90 offset:640
    ds_write_b32 v7, v91 offset:8832
    v_lshlrev_b32 v112, 16, v19
    v_and_b32 v113, s34, v19
    v_lshlrev_b32 v114, 16, v23
    v_and_b32 v115, s34, v23
    v_lshlrev_b32 v116, 16, v27
    v_and_b32 v117, s34, v27
    v_lshlrev_b32 v118, 16, v31
    v_and_b32 v119, s34, v31
    v_lshlrev_b32 v120, 16, v35
    v_and_b32 v121, s34, v35
    v_lshlrev_b32 v122, 16, v39
    v_and_b32 v123, s34, v39
    v_lshlrev_b32 v124, 16, v43
    v_and_b32 v125, s34, v43
    v_lshlrev_b32 v126, 16, v47
    v_and_b32 v127, s34, v47
    v_lshlrev_b32 v128, 16, v51
    v_and_b32 v129, s34, v51
    v_lshlrev_b32 v130, 16, v64
    v_and_b32 v132, s34, v64
    v_lshlrev_b32 v134, 16, v65
    v_and_b32 v136, s34, v65
    v_lshlrev_b32 v131, 16, v66
    v_and_b32 v133, s34, v66
    v_lshlrev_b32 v135, 16, v67
    v_and_b32 v137, s34, v67
    v_pk_mul_f32 v[138:139], v[112:113], v[136:137]
    v_pk_mul_f32 v[140:141], v[114:115], v[136:137]
    v_pk_mul_f32 v[142:143], v[116:117], v[136:137]
    v_pk_fma_f32 v[138:139], v[114:115], v[134:135], v[138:139]
    v_pk_fma_f32 v[140:141], v[116:117], v[134:135], v[140:141]
    v_pk_fma_f32 v[142:143], v[118:119], v[134:135], v[142:143]
    v_pk_fma_f32 v[138:139], v[116:117], v[132:133], v[138:139]
    v_pk_fma_f32 v[140:141], v[118:119], v[132:133], v[140:141]
    v_pk_fma_f32 v[142:143], v[120:121], v[132:133], v[142:143]
    v_pk_fma_f32 v[138:139], v[118:119], v[130:131], v[138:139]
    v_pk_fma_f32 v[140:141], v[120:121], v[130:131], v[140:141]
    v_pk_fma_f32 v[142:143], v[122:123], v[130:131], v[142:143]
    v_pk_mul_f32 v[138:139], v[138:139], v[124:125]
    v_pk_mul_f32 v[140:141], v[140:141], v[126:127]
    v_pk_mul_f32 v[142:143], v[142:143], v[128:129]
    v_cvt_pk_bf16_f32 v88, v140, v138
    v_cvt_pk_bf16_f32 v89, v142, v140
    ds_write_b32 v7, v88 offset:768
    ds_write_b32 v7, v89 offset:8960
    v_cvt_pk_bf16_f32 v90, v141, v139
    v_cvt_pk_bf16_f32 v91, v143, v141
    ds_write_b32 v7, v90 offset:896
    ds_write_b32 v7, v91 offset:9088
    v_lshrrev_b32 v8, 6, v101
    v_xor_b32 v9, v2, v8
    v_lshlrev_b32 v9, 4, v9
    v_lshl_add_u32 v9, v1, 7, v9
    v_xor_b32 v10, 64, v9
    v_add_u32 v9, s70, v9
    v_add_u32 v10, s70, v10
    s_lshl_b32 s35, s29, 19
    s_sub_u32 s36, 1984, s30
    s_lshl_b32 s36, s36, 1
    s_add_u32 s35, s35, s36
    v_lshlrev_b32 v11, 13, v1
    v_add3_u32 v11, v11, v5, s35
    v_add_u32 v12, 0x40000, v11
    s_waitcnt lgkmcnt(0)
    s_barrier
    ds_read_b128 v[16:19], v9
    ds_read_b128 v[20:23], v10 offset:4096
    ds_read_b128 v[24:27], v9 offset:8192
    ds_read_b128 v[28:31], v10 offset:12288
    s_movk_i32 s37, 0x1000
    s_waitcnt lgkmcnt(3)
    buffer_store_dwordx4 v[16:19], v11, s[20:23], 0 offen sc1
    s_waitcnt lgkmcnt(2)
    buffer_store_dwordx4 v[20:23], v12, s[20:23], 0 offen sc1
    s_waitcnt lgkmcnt(1)
    buffer_store_dwordx4 v[24:27], v11, s[20:23], s37 offen sc1
    s_waitcnt lgkmcnt(0)
    buffer_store_dwordx4 v[28:31], v12, s[20:23], s37 offen sc1

    v_mov_b32 v2, v100
    v_mov_b32 v4, v103
    v_mov_b32 v5, v104
    s_mov_b32 s30, s68
    s_lshl_b32 s32, s63, 13
    s_add_u32 s32, s32, 0
    s_lshl_b32 s33, s2, 14
    s_add_u32 s33, s33, 7077888

    s_add_u32 s12, s26, s32
    s_addc_u32 s13, s27, 0
    s_mov_b32 s14, 0x2000
    s_mov_b32 s15, 0x00020000
    s_add_u32 s16, s26, s33
    s_addc_u32 s17, s27, 0
    s_mov_b32 s18, 0x4000
    s_mov_b32 s19, 0x00020000
    s_add_u32 s20, s26, 0x2f40000
    s_addc_u32 s21, s27, 0
    s_mov_b32 s22, 0x4000
    s_mov_b32 s23, 0x00020000
    s_lshr_b32 s33, s2, 1
    s_lshl_b32 s33, s33, 15
    s_add_u32 s33, s33, 9437184
    s_add_u32 s44, s26, s33
    s_addc_u32 s45, s27, 0
    s_mov_b32 s46, 0x8000
    s_mov_b32 s47, 0x00020000
    s_add_u32 s40, s26, 0x2640000
    s_addc_u32 s41, s27, 0
    s_mov_b32 s42, 0xa400
    s_mov_b32 s43, 0x00020000
    s_lshl_b32 s36, s2, 11
    v_lshlrev_b32 v8, 2, v0
    v_mov_b32 v12, 0
    v_mov_b32 v13, 0
    v_mov_b32 v14, 0
    v_mov_b32 v15, 0
    buffer_store_dword v12, v8, s[40:43], s36 offen
    s_movk_i32 s38, 4160
    v_mul_lo_u32 v8, v4, s38
    v_lshl_add_u32 v8, v5, 2, v8
    v_add_u32 v8, s30, v8
    v_lshrrev_b32 v9, 5, v2
    s_movk_i32 s38, 4640
    v_mul_lo_u32 v9, v9, s38
    v_and_b32 v10, 31, v2
    v_lshl_add_u32 v9, v10, 4, v9
    s_add_u32 s39, s30, 20736
    v_add_u32 v9, s39, v9
    ds_write_b128 v9, v[12:15]
    v_and_b32 v10, 3, v5
    s_movk_i32 s38, 4160
    v_mul_lo_u32 v10, v10, s38
    v_lshrrev_b32 v11, 2, v5
    v_add_u32 v11, v11, v4
    v_lshl_add_u32 v10, v11, 4, v10
    v_add_u32 v10, s30, v10
    v_and_b32 v11, 1, v5
    s_movk_i32 s38, 4640
    v_mul_lo_u32 v11, v11, s38
    v_lshrrev_b32 v6, 1, v5
    v_lshlrev_b32 v6, 2, v6
    v_sub_u32 v6, v4, v6
    v_add_u32 v6, 28, v6
    v_lshl_add_u32 v11, v6, 4, v11
    s_add_u32 s39, s30, 16640
    v_add_u32 v11, s39, v11
    s_and_b32 s40, s63, 1
    s_lshl_b32 s40, s40, 4
    s_lshr_b32 s35, s69, s40
    s_and_b32 s35, s35, 0xffff
    v_lshl_add_u32 v6, v4, 2, v5
    v_mov_b32 v7, s35

    v_cmp_eq_u32 vcc, 15, v6
    s_nop 1
    v_cndmask_b32 v108, 0, v7, vcc
    v_cmp_eq_u32 vcc, 14, v6
    s_nop 1
    v_cndmask_b32 v109, 0, v7, vcc
    v_cmp_eq_u32 vcc, 13, v6
    s_nop 1
    v_cndmask_b32 v110, 0, v7, vcc
    v_cmp_eq_u32 vcc, 12, v6
    s_nop 1
    v_cndmask_b32 v111, 0, v7, vcc
    s_lshl_b32 s34, s29, 4
    v_and_b32 v6, 3, v2
    v_lshlrev_b32 v6, 2, v6
    v_add_u32 v6, s34, v6
    v_and_b32 v7, 15, v2
    v_lshlrev_b32 v12, 2, v7
    v_lshlrev_b32 v7, 7, v7
    s_lshl_b32 s34, s29, 11
    s_and_b32 s35, s2, 15
    s_lshl_b32 s35, s35, 2
    s_add_u32 s34, s34, s35
    v_mov_b32 v13, 1
    v_mov_b32 v14, s2
    s_mul_i32 s36, s61, 4640
    s_add_u32 s36, s36, s39
    s_lshl_b32 s37, s61, 12
    s_waitcnt vmcnt(0)
    s_barrier

    s_mov_b32 s33, s37
    s_cmp_lg_u32 s60, 7
    s_cbranch_scc1 ka_nb
    s_mov_b64 exec, 1
    buffer_store_byte v13, v14, s[52:55], 0 offen sc1
    s_mov_b64 exec, -1

ka_nb:
    s_cmp_lg_u32 s60, 0
    s_cbranch_scc1 ka_go
    s_mov_b64 exec, 0xffff
    buffer_store_dword v13, v7, s[56:59], s34 offen sc1
    s_mov_b64 exec, -1
    s_mov_b32 s38, 0
    s_mov_b32 s35, 0x01010101

ka_poll:
    buffer_load_dword v15, v12, s[56:59], s71 offen sc1
    s_add_u32 s38, s38, 1
    s_waitcnt vmcnt(0)
    v_cmp_ne_u32 vcc, 1, v15
    s_and_b32 s34, s38, 15
    s_cbranch_vccz ka_go
    s_cmp_lg_u32 s34, 0
    s_cbranch_scc1 ka_poll
    buffer_load_dword v15, v6, s[52:55], 0 offen sc1
    s_waitcnt vmcnt(0)
    v_cmp_ne_u32 vcc, s35, v15
    s_cmp_ge_u32 s38, 0x8000
    s_cbranch_scc1 ka_go
    s_cbranch_vccnz ka_poll

ka_go:
    s_cmp_eq_u32 s60, 0
    s_cbranch_scc1 ka_k0
ka_kk:
    s_add_u32 m0, s25, 64
    s_add_u32 s37, s24, 4
    buffer_load_dwordx4 v102, s[8:11], s37 offen offset:0 lds
    buffer_load_dwordx4 v102, s[8:11], s37 offen offset:1024 lds
    s_add_u32 m0, s25, 4224
    s_add_u32 s37, s24, 8
    buffer_load_dwordx4 v102, s[8:11], s37 offen offset:0 lds
    buffer_load_dwordx4 v102, s[8:11], s37 offen offset:1024 lds
    s_add_u32 m0, s25, 8384
    s_add_u32 s37, s24, 12
    buffer_load_dwordx4 v102, s[8:11], s37 offen offset:0 lds
    buffer_load_dwordx4 v102, s[8:11], s37 offen offset:1024 lds
    s_add_u32 m0, s25, 12544
    s_add_u32 s37, s24, 16
    buffer_load_dwordx4 v102, s[8:11], s37 offen offset:0 lds
    buffer_load_dwordx4 v102, s[8:11], s37 offen offset:1024 lds
    s_sub_u32 s34, s60, 4
    s_lshr_b32 s35, s24, 11
    s_xor_b32 s35, s35, 1
    s_or_b32 s34, s34, s35
    s_mov_b32 s24, 0
    s_mov_b32 s25, 0
    s_cmp_eq_u32 s34, 0
    s_cbranch_scc1 ka_kk

ka_k0:
    s_mov_b32 s37, s33
    s_mov_b32 m0, s36
    s_barrier
    buffer_load_dwordx4 v102, s[12:15], s37 offen offset:0 sc1 lds
    buffer_load_dwordx4 v102, s[12:15], s37 offen offset:1024 sc1 lds
    buffer_load_dwordx4 v102, s[12:15], s37 offen offset:2048 sc1 lds
    buffer_load_dwordx4 v102, s[12:15], s37 offen offset:3072 sc1 lds
    s_cmp_lg_u32 s61, 0
    s_cbranch_scc1 ka_epi
    s_waitcnt vmcnt(0)
    ds_write_b32 v8, v105
    s_waitcnt lgkmcnt(0)
    s_barrier

    s_setprio 3
    ds_read_b128 v[140:143], v11 offset:0
    ds_read_b128 v[136:139], v11 offset:512
    ds_read_b128 v[132:135], v11 offset:1024
    ds_read_b128 v[128:131], v11 offset:1536
    ds_read_b128 v[124:127], v11 offset:2048
    ds_read_b128 v[120:123], v11 offset:2560
    ds_read_b128 v[116:119], v11 offset:3072
    ds_read_b128 v[112:115], v11 offset:3584
    ds_read_b128 v[64:67], v10 offset:0
    ds_read_b128 v[68:71], v10 offset:512
    ds_read_b128 v[72:75], v10 offset:1024
    ds_read_b128 v[76:79], v10 offset:1536
    s_mov_b32 s38, 0
    s_waitcnt lgkmcnt(11)
    v_mfma_f32_16x16x32_bf16 v[60:63], v[140:143], v[108:111], 0
    ds_read_b128 v[80:83], v10 offset:2048
    s_waitcnt lgkmcnt(11)
    v_mfma_f32_16x16x32_bf16 v[56:59], v[136:139], v[108:111], 0
    ds_read_b128 v[84:87], v10 offset:2560
    s_waitcnt lgkmcnt(11)
    v_mfma_f32_16x16x32_bf16 v[52:55], v[132:135], v[108:111], 0
    ds_read_b128 v[88:91], v10 offset:3072
    s_waitcnt lgkmcnt(11)
    v_mfma_f32_16x16x32_bf16 v[48:51], v[128:131], v[108:111], 0
    s_waitcnt lgkmcnt(10)
    v_mfma_f32_16x16x32_bf16 v[44:47], v[124:127], v[108:111], 0
    s_waitcnt lgkmcnt(9)
    v_mfma_f32_16x16x32_bf16 v[40:43], v[120:123], v[108:111], 0
    s_waitcnt lgkmcnt(8)
    v_mfma_f32_16x16x32_bf16 v[36:39], v[116:119], v[108:111], 0
    s_waitcnt lgkmcnt(7)
    v_mfma_f32_16x16x32_bf16 v[32:35], v[112:115], v[108:111], 0
    s_waitcnt lgkmcnt(0)
ka_cl:
    s_waitcnt lgkmcnt(3)
    v_mfma_f32_16x16x32_bf16 v[60:63], v[140:143], v[64:67], v[60:63]
    ds_read_b128 v[92:95], v10 offset:3584
    v_mfma_f32_16x16x32_bf16 v[56:59], v[136:139], v[64:67], v[56:59]
    v_mfma_f32_16x16x32_bf16 v[52:55], v[132:135], v[64:67], v[52:55]
    v_mfma_f32_16x16x32_bf16 v[48:51], v[128:131], v[64:67], v[48:51]
    ds_read_b128 v[172:175], v11 offset:64
    v_mfma_f32_16x16x32_bf16 v[44:47], v[124:127], v[64:67], v[44:47]
    v_mfma_f32_16x16x32_bf16 v[40:43], v[120:123], v[64:67], v[40:43]
    v_mfma_f32_16x16x32_bf16 v[36:39], v[116:119], v[64:67], v[36:39]
    ds_read_b128 v[168:171], v11 offset:576
    v_mfma_f32_16x16x32_bf16 v[32:35], v[112:115], v[64:67], v[32:35]
    v_mfma_f32_16x16x32_bf16 v[60:63], v[136:139], v[68:71], v[60:63]
    ds_read_b128 v[64:67], v10 offset:64
    v_mfma_f32_16x16x32_bf16 v[56:59], v[132:135], v[68:71], v[56:59]
    ds_read_b128 v[164:167], v11 offset:1088
    v_mfma_f32_16x16x32_bf16 v[52:55], v[128:131], v[68:71], v[52:55]
    v_mfma_f32_16x16x32_bf16 v[48:51], v[124:127], v[68:71], v[48:51]
    v_mfma_f32_16x16x32_bf16 v[44:47], v[120:123], v[68:71], v[44:47]
    ds_read_b128 v[160:163], v11 offset:1600
    v_mfma_f32_16x16x32_bf16 v[40:43], v[116:119], v[68:71], v[40:43]
    v_mfma_f32_16x16x32_bf16 v[36:39], v[112:115], v[68:71], v[36:39]
    v_mfma_f32_16x16x32_bf16 v[60:63], v[132:135], v[72:75], v[60:63]
    ds_read_b128 v[68:71], v10 offset:576
    v_mfma_f32_16x16x32_bf16 v[56:59], v[128:131], v[72:75], v[56:59]
    ds_read_b128 v[156:159], v11 offset:2112
    v_mfma_f32_16x16x32_bf16 v[52:55], v[124:127], v[72:75], v[52:55]
    v_mfma_f32_16x16x32_bf16 v[48:51], v[120:123], v[72:75], v[48:51]
    ds_read_b128 v[152:155], v11 offset:2624
    v_mfma_f32_16x16x32_bf16 v[44:47], v[116:119], v[72:75], v[44:47]
    v_mfma_f32_16x16x32_bf16 v[40:43], v[112:115], v[72:75], v[40:43]
    v_mfma_f32_16x16x32_bf16 v[60:63], v[128:131], v[76:79], v[60:63]
    ds_read_b128 v[72:75], v10 offset:1088
    v_mfma_f32_16x16x32_bf16 v[56:59], v[124:127], v[76:79], v[56:59]
    ds_read_b128 v[148:151], v11 offset:3136
    v_mfma_f32_16x16x32_bf16 v[52:55], v[120:123], v[76:79], v[52:55]
    v_mfma_f32_16x16x32_bf16 v[48:51], v[116:119], v[76:79], v[48:51]
    ds_read_b128 v[144:147], v11 offset:3648
    v_mfma_f32_16x16x32_bf16 v[44:47], v[112:115], v[76:79], v[44:47]
    s_waitcnt lgkmcnt(14)
    v_mfma_f32_16x16x32_bf16 v[60:63], v[124:127], v[80:83], v[60:63]
    ds_read_b128 v[76:79], v10 offset:1600
    v_mfma_f32_16x16x32_bf16 v[56:59], v[120:123], v[80:83], v[56:59]
    v_mfma_f32_16x16x32_bf16 v[52:55], v[116:119], v[80:83], v[52:55]
    v_mfma_f32_16x16x32_bf16 v[48:51], v[112:115], v[80:83], v[48:51]
    s_waitcnt lgkmcnt(14)
    v_mfma_f32_16x16x32_bf16 v[60:63], v[120:123], v[84:87], v[60:63]
    ds_read_b128 v[80:83], v10 offset:2112
    v_mfma_f32_16x16x32_bf16 v[56:59], v[116:119], v[84:87], v[56:59]
    v_mfma_f32_16x16x32_bf16 v[52:55], v[112:115], v[84:87], v[52:55]
    s_waitcnt lgkmcnt(14)
    v_mfma_f32_16x16x32_bf16 v[60:63], v[116:119], v[88:91], v[60:63]
    ds_read_b128 v[84:87], v10 offset:2624
    v_mfma_f32_16x16x32_bf16 v[56:59], v[112:115], v[88:91], v[56:59]
    s_waitcnt lgkmcnt(14)
    v_mfma_f32_16x16x32_bf16 v[60:63], v[112:115], v[92:95], v[60:63]
    ds_read_b128 v[88:91], v10 offset:3136
    s_waitcnt lgkmcnt(12)
    v_mfma_f32_16x16x32_bf16 v[60:63], v[172:175], v[64:67], v[60:63]
    ds_read_b128 v[92:95], v10 offset:3648
    v_mfma_f32_16x16x32_bf16 v[56:59], v[168:171], v[64:67], v[56:59]
    s_waitcnt lgkmcnt(12)
    v_mfma_f32_16x16x32_bf16 v[52:55], v[164:167], v[64:67], v[52:55]
    s_waitcnt lgkmcnt(11)
    v_mfma_f32_16x16x32_bf16 v[48:51], v[160:163], v[64:67], v[48:51]
    ds_read_b128 v[140:143], v11 offset:128
    s_waitcnt lgkmcnt(10)
    v_mfma_f32_16x16x32_bf16 v[44:47], v[156:159], v[64:67], v[44:47]
    s_waitcnt lgkmcnt(9)
    v_mfma_f32_16x16x32_bf16 v[40:43], v[152:155], v[64:67], v[40:43]
    s_waitcnt lgkmcnt(7)
    v_mfma_f32_16x16x32_bf16 v[36:39], v[148:151], v[64:67], v[36:39]
    ds_read_b128 v[136:139], v11 offset:640
    s_waitcnt lgkmcnt(7)
    v_mfma_f32_16x16x32_bf16 v[32:35], v[144:147], v[64:67], v[32:35]
    v_mfma_f32_16x16x32_bf16 v[60:63], v[168:171], v[68:71], v[60:63]
    ds_read_b128 v[64:67], v10 offset:128
    v_mfma_f32_16x16x32_bf16 v[56:59], v[164:167], v[68:71], v[56:59]
    ds_read_b128 v[132:135], v11 offset:1152
    v_mfma_f32_16x16x32_bf16 v[52:55], v[160:163], v[68:71], v[52:55]
    v_mfma_f32_16x16x32_bf16 v[48:51], v[156:159], v[68:71], v[48:51]
    v_mfma_f32_16x16x32_bf16 v[44:47], v[152:155], v[68:71], v[44:47]
    ds_read_b128 v[128:131], v11 offset:1664
    v_mfma_f32_16x16x32_bf16 v[40:43], v[148:151], v[68:71], v[40:43]
    v_mfma_f32_16x16x32_bf16 v[36:39], v[144:147], v[68:71], v[36:39]
    v_mfma_f32_16x16x32_bf16 v[60:63], v[164:167], v[72:75], v[60:63]
    ds_read_b128 v[68:71], v10 offset:640
    v_mfma_f32_16x16x32_bf16 v[56:59], v[160:163], v[72:75], v[56:59]
    ds_read_b128 v[124:127], v11 offset:2176
    v_mfma_f32_16x16x32_bf16 v[52:55], v[156:159], v[72:75], v[52:55]
    v_mfma_f32_16x16x32_bf16 v[48:51], v[152:155], v[72:75], v[48:51]
    ds_read_b128 v[120:123], v11 offset:2688
    v_mfma_f32_16x16x32_bf16 v[44:47], v[148:151], v[72:75], v[44:47]
    v_mfma_f32_16x16x32_bf16 v[40:43], v[144:147], v[72:75], v[40:43]
    s_waitcnt lgkmcnt(12)
    v_mfma_f32_16x16x32_bf16 v[60:63], v[160:163], v[76:79], v[60:63]
    ds_read_b128 v[72:75], v10 offset:1152
    v_mfma_f32_16x16x32_bf16 v[56:59], v[156:159], v[76:79], v[56:59]
    ds_read_b128 v[116:119], v11 offset:3200
    v_mfma_f32_16x16x32_bf16 v[52:55], v[152:155], v[76:79], v[52:55]
    v_mfma_f32_16x16x32_bf16 v[48:51], v[148:151], v[76:79], v[48:51]
    ds_read_b128 v[112:115], v11 offset:3712
    v_mfma_f32_16x16x32_bf16 v[44:47], v[144:147], v[76:79], v[44:47]
    s_waitcnt lgkmcnt(14)
    v_mfma_f32_16x16x32_bf16 v[60:63], v[156:159], v[80:83], v[60:63]
    ds_read_b128 v[76:79], v10 offset:1664
    v_mfma_f32_16x16x32_bf16 v[56:59], v[152:155], v[80:83], v[56:59]
    v_mfma_f32_16x16x32_bf16 v[52:55], v[148:151], v[80:83], v[52:55]
    v_mfma_f32_16x16x32_bf16 v[48:51], v[144:147], v[80:83], v[48:51]
    s_waitcnt lgkmcnt(14)
    v_mfma_f32_16x16x32_bf16 v[60:63], v[152:155], v[84:87], v[60:63]
    ds_read_b128 v[80:83], v10 offset:2176
    v_mfma_f32_16x16x32_bf16 v[56:59], v[148:151], v[84:87], v[56:59]
    v_mfma_f32_16x16x32_bf16 v[52:55], v[144:147], v[84:87], v[52:55]
    s_waitcnt lgkmcnt(14)
    v_mfma_f32_16x16x32_bf16 v[60:63], v[148:151], v[88:91], v[60:63]
    ds_read_b128 v[84:87], v10 offset:2688
    v_mfma_f32_16x16x32_bf16 v[56:59], v[144:147], v[88:91], v[56:59]
    s_waitcnt lgkmcnt(14)
    v_mfma_f32_16x16x32_bf16 v[60:63], v[144:147], v[92:95], v[60:63]
    ds_read_b128 v[88:91], v10 offset:3200
    v_add_u32 v10, 128, v10
    v_add_u32 v11, 128, v11
    s_add_u32 s38, s38, 1
    s_cmp_lt_u32 s38, 4
    s_cbranch_scc1 ka_cl
    s_waitcnt lgkmcnt(0)

    v_lshlrev_b32 v16, 7, v4
    v_lshl_add_u32 v16, v5, 2, v16
    v_add_u32 v16, s30, v16
    s_nop 7

    v_cvt_pk_bf16_f32 v32, v32, v33
    v_cvt_pk_bf16_f32 v33, v34, v35
    ds_write_b32 v16, v32 offset:0
    ds_write_b32 v16, v33 offset:64
    v_cvt_pk_bf16_f32 v36, v36, v37
    v_cvt_pk_bf16_f32 v37, v38, v39
    ds_write_b32 v16, v36 offset:512
    ds_write_b32 v16, v37 offset:576
    v_cvt_pk_bf16_f32 v40, v40, v41
    v_cvt_pk_bf16_f32 v41, v42, v43
    ds_write_b32 v16, v40 offset:1024
    ds_write_b32 v16, v41 offset:1088
    v_cvt_pk_bf16_f32 v44, v44, v45
    v_cvt_pk_bf16_f32 v45, v46, v47
    ds_write_b32 v16, v44 offset:1536
    ds_write_b32 v16, v45 offset:1600
    v_cvt_pk_bf16_f32 v48, v48, v49
    v_cvt_pk_bf16_f32 v49, v50, v51
    ds_write_b32 v16, v48 offset:2048
    ds_write_b32 v16, v49 offset:2112
    v_cvt_pk_bf16_f32 v52, v52, v53
    v_cvt_pk_bf16_f32 v53, v54, v55
    ds_write_b32 v16, v52 offset:2560
    ds_write_b32 v16, v53 offset:2624
    v_cvt_pk_bf16_f32 v56, v56, v57
    v_cvt_pk_bf16_f32 v57, v58, v59
    ds_write_b32 v16, v56 offset:3072
    ds_write_b32 v16, v57 offset:3136
    v_cvt_pk_bf16_f32 v60, v60, v61
    v_cvt_pk_bf16_f32 v61, v62, v63
    ds_write_b32 v16, v60 offset:3584
    ds_write_b32 v16, v61 offset:3648
    s_waitcnt lgkmcnt(0)
    s_barrier
    s_endpgm
ka_epi:
    v_lshlrev_b32 v16, 4, v101
    v_lshlrev_b32 v17, 2, v101
    v_lshlrev_b32 v18, 5, v101
    v_min_u32 v6, 27, v2
    v_lshlrev_b32 v6, 2, v6
    s_mov_b32 s35, 0x01010101
    s_mov_b32 s38, 0

    s_movk_i32 s37, 0
    buffer_load_dwordx4 v[80:83], v16, s[16:19], s37 offen sc1
    s_movk_i32 s37, 4096
    buffer_load_dwordx4 v[88:91], v16, s[16:19], s37 offen sc1
    s_movk_i32 s37, 8192
    buffer_load_dwordx4 v[96:99], v16, s[16:19], s37 offen sc1
    s_movk_i32 s37, 12288
    buffer_load_dwordx4 v[104:107], v16, s[16:19], s37 offen sc1
    s_waitcnt vmcnt(4) lgkmcnt(0)
    s_barrier

ka_poll2:
    buffer_load_dword v15, v6, s[52:55], 0 offen offset:144 sc1
    s_add_u32 s38, s38, 1
    s_waitcnt vmcnt(0)
    v_cmp_ne_u32 vcc, s35, v15
    s_cmp_ge_u32 s38, 0x8000
    s_cbranch_scc1 ka_go2
    s_cbranch_vccnz ka_poll2

ka_go2:
    s_movk_i32 s37, 0
    buffer_load_dwordx4 v[84:87], v16, s[20:23], s37 offen sc1
    s_movk_i32 s37, 4096
    buffer_load_dwordx4 v[92:95], v16, s[20:23], s37 offen sc1
    s_movk_i32 s37, 8192
    buffer_load_dwordx4 v[100:103], v16, s[20:23], s37 offen sc1
    s_movk_i32 s37, 12288
    buffer_load_dwordx4 v[108:111], v16, s[20:23], s37 offen sc1
    s_and_b32 s40, s2, 1
    s_lshl_b32 s40, s40, 3
    v_add_u32 v18, s40, v18
    s_mov_b32 s41, 0xffff0000
    v_add_u32 v19, 51840, v17
    s_waitcnt vmcnt(0)

    v_lshlrev_b32 v112, 16, v80
    v_and_b32 v113, s41, v80
    v_lshlrev_b32 v114, 16, v81
    v_and_b32 v115, s41, v81
    v_sub_f32 v144, v112, v84
    v_sub_f32 v145, v113, v84
    v_sub_f32 v146, v114, v84
    v_sub_f32 v147, v115, v84
    v_mul_f32 v144, v144, v85
    v_mul_f32 v145, v145, v85
    v_mul_f32 v146, v146, v85
    v_mul_f32 v147, v147, v85
    v_lshlrev_b32 v116, 16, v82
    v_and_b32 v117, s41, v82
    v_lshlrev_b32 v118, 16, v83
    v_and_b32 v119, s41, v83
    v_sub_f32 v148, v116, v86
    v_sub_f32 v149, v117, v86
    v_sub_f32 v150, v118, v86
    v_sub_f32 v151, v119, v86
    v_mul_f32 v148, v148, v87
    v_mul_f32 v149, v149, v87
    v_mul_f32 v150, v150, v87
    v_mul_f32 v151, v151, v87
    v_lshlrev_b32 v120, 16, v88
    v_and_b32 v121, s41, v88
    v_lshlrev_b32 v122, 16, v89
    v_and_b32 v123, s41, v89
    v_sub_f32 v152, v120, v92
    v_sub_f32 v153, v121, v92
    v_sub_f32 v154, v122, v92
    v_sub_f32 v155, v123, v92
    v_mul_f32 v152, v152, v93
    v_mul_f32 v153, v153, v93
    v_mul_f32 v154, v154, v93
    v_mul_f32 v155, v155, v93
    v_lshlrev_b32 v124, 16, v90
    v_and_b32 v125, s41, v90
    v_lshlrev_b32 v126, 16, v91
    v_and_b32 v127, s41, v91
    v_sub_f32 v156, v124, v94
    v_sub_f32 v157, v125, v94
    v_sub_f32 v158, v126, v94
    v_sub_f32 v159, v127, v94
    v_mul_f32 v156, v156, v95
    v_mul_f32 v157, v157, v95
    v_mul_f32 v158, v158, v95
    v_mul_f32 v159, v159, v95
    v_lshlrev_b32 v128, 16, v96
    v_and_b32 v129, s41, v96
    v_lshlrev_b32 v130, 16, v97
    v_and_b32 v131, s41, v97
    v_sub_f32 v160, v128, v100
    v_sub_f32 v161, v129, v100
    v_sub_f32 v162, v130, v100
    v_sub_f32 v163, v131, v100
    v_mul_f32 v160, v160, v101
    v_mul_f32 v161, v161, v101
    v_mul_f32 v162, v162, v101
    v_mul_f32 v163, v163, v101
    v_lshlrev_b32 v132, 16, v98
    v_and_b32 v133, s41, v98
    v_lshlrev_b32 v134, 16, v99
    v_and_b32 v135, s41, v99
    v_sub_f32 v164, v132, v102
    v_sub_f32 v165, v133, v102
    v_sub_f32 v166, v134, v102
    v_sub_f32 v167, v135, v102
    v_mul_f32 v164, v164, v103
    v_mul_f32 v165, v165, v103
    v_mul_f32 v166, v166, v103
    v_mul_f32 v167, v167, v103
    v_lshlrev_b32 v136, 16, v104
    v_and_b32 v137, s41, v104
    v_lshlrev_b32 v138, 16, v105
    v_and_b32 v139, s41, v105
    v_sub_f32 v168, v136, v108
    v_sub_f32 v169, v137, v108
    v_sub_f32 v170, v138, v108
    v_sub_f32 v171, v139, v108
    v_mul_f32 v168, v168, v109
    v_mul_f32 v169, v169, v109
    v_mul_f32 v170, v170, v109
    v_mul_f32 v171, v171, v109
    v_lshlrev_b32 v140, 16, v106
    v_and_b32 v141, s41, v106
    v_lshlrev_b32 v142, 16, v107
    v_and_b32 v143, s41, v107
    v_sub_f32 v172, v140, v110
    v_sub_f32 v173, v141, v110
    v_sub_f32 v174, v142, v110
    v_sub_f32 v175, v143, v110
    v_mul_f32 v172, v172, v111
    v_mul_f32 v173, v173, v111
    v_mul_f32 v174, v174, v111
    v_mul_f32 v175, v175, v111
    s_barrier
    ds_read_b32 v64, v17 offset:0
    ds_read_b32 v65, v17 offset:25920
    ds_read_b32 v66, v19 offset:0
    ds_read_b32 v67, v19 offset:25920
    ds_read_b32 v68, v17 offset:1024
    ds_read_b32 v69, v17 offset:26944
    ds_read_b32 v70, v19 offset:1024
    ds_read_b32 v71, v19 offset:26944
    ds_read_b32 v72, v17 offset:2048
    ds_read_b32 v73, v17 offset:27968
    ds_read_b32 v74, v19 offset:2048
    ds_read_b32 v75, v19 offset:27968
    ds_read_b32 v76, v17 offset:3072
    ds_read_b32 v77, v17 offset:28992
    ds_read_b32 v78, v19 offset:3072
    ds_read_b32 v79, v19 offset:28992
    s_waitcnt lgkmcnt(12)
    s_movk_i32 s37, 0
    v_lshlrev_b32 v36, 16, v64
    v_lshlrev_b32 v37, 16, v65
    v_lshlrev_b32 v38, 16, v66
    v_lshlrev_b32 v39, 16, v67
    v_pk_fma_f32 v[112:113], v[144:145], v[36:37], v[112:113]
    v_pk_fma_f32 v[114:115], v[146:147], v[38:39], v[114:115]
    v_cvt_pk_bf16_f32 v44, v112, v113
    v_cvt_pk_bf16_f32 v45, v114, v115
    buffer_store_dwordx2 v[44:45], v18, s[44:47], s37 offen offset:0
    v_and_b32 v36, s41, v64
    v_and_b32 v37, s41, v65
    v_and_b32 v38, s41, v66
    v_and_b32 v39, s41, v67
    v_pk_fma_f32 v[116:117], v[148:149], v[36:37], v[116:117]
    v_pk_fma_f32 v[118:119], v[150:151], v[38:39], v[118:119]
    v_cvt_pk_bf16_f32 v46, v116, v117
    v_cvt_pk_bf16_f32 v47, v118, v119
    buffer_store_dwordx2 v[46:47], v18, s[44:47], s37 offen offset:16
    s_waitcnt lgkmcnt(8)
    s_movk_i32 s37, 8192
    v_lshlrev_b32 v36, 16, v68
    v_lshlrev_b32 v37, 16, v69
    v_lshlrev_b32 v38, 16, v70
    v_lshlrev_b32 v39, 16, v71
    v_pk_fma_f32 v[120:121], v[152:153], v[36:37], v[120:121]
    v_pk_fma_f32 v[122:123], v[154:155], v[38:39], v[122:123]
    v_cvt_pk_bf16_f32 v48, v120, v121
    v_cvt_pk_bf16_f32 v49, v122, v123
    buffer_store_dwordx2 v[48:49], v18, s[44:47], s37 offen offset:0
    v_and_b32 v36, s41, v68
    v_and_b32 v37, s41, v69
    v_and_b32 v38, s41, v70
    v_and_b32 v39, s41, v71
    v_pk_fma_f32 v[124:125], v[156:157], v[36:37], v[124:125]
    v_pk_fma_f32 v[126:127], v[158:159], v[38:39], v[126:127]
    v_cvt_pk_bf16_f32 v50, v124, v125
    v_cvt_pk_bf16_f32 v51, v126, v127
    buffer_store_dwordx2 v[50:51], v18, s[44:47], s37 offen offset:16
    s_waitcnt lgkmcnt(4)
    s_movk_i32 s37, 16384
    v_lshlrev_b32 v36, 16, v72
    v_lshlrev_b32 v37, 16, v73
    v_lshlrev_b32 v38, 16, v74
    v_lshlrev_b32 v39, 16, v75
    v_pk_fma_f32 v[128:129], v[160:161], v[36:37], v[128:129]
    v_pk_fma_f32 v[130:131], v[162:163], v[38:39], v[130:131]
    v_cvt_pk_bf16_f32 v44, v128, v129
    v_cvt_pk_bf16_f32 v45, v130, v131
    buffer_store_dwordx2 v[44:45], v18, s[44:47], s37 offen offset:0
    v_and_b32 v36, s41, v72
    v_and_b32 v37, s41, v73
    v_and_b32 v38, s41, v74
    v_and_b32 v39, s41, v75
    v_pk_fma_f32 v[132:133], v[164:165], v[36:37], v[132:133]
    v_pk_fma_f32 v[134:135], v[166:167], v[38:39], v[134:135]
    v_cvt_pk_bf16_f32 v46, v132, v133
    v_cvt_pk_bf16_f32 v47, v134, v135
    buffer_store_dwordx2 v[46:47], v18, s[44:47], s37 offen offset:16
    s_waitcnt lgkmcnt(0)
    s_movk_i32 s37, 24576
    v_lshlrev_b32 v36, 16, v76
    v_lshlrev_b32 v37, 16, v77
    v_lshlrev_b32 v38, 16, v78
    v_lshlrev_b32 v39, 16, v79
    v_pk_fma_f32 v[136:137], v[168:169], v[36:37], v[136:137]
    v_pk_fma_f32 v[138:139], v[170:171], v[38:39], v[138:139]
    v_cvt_pk_bf16_f32 v48, v136, v137
    v_cvt_pk_bf16_f32 v49, v138, v139
    buffer_store_dwordx2 v[48:49], v18, s[44:47], s37 offen offset:0
    v_and_b32 v36, s41, v76
    v_and_b32 v37, s41, v77
    v_and_b32 v38, s41, v78
    v_and_b32 v39, s41, v79
    v_pk_fma_f32 v[140:141], v[172:173], v[36:37], v[140:141]
    v_pk_fma_f32 v[142:143], v[174:175], v[38:39], v[142:143]
    v_cvt_pk_bf16_f32 v50, v140, v141
    v_cvt_pk_bf16_f32 v51, v142, v143
    buffer_store_dwordx2 v[50:51], v18, s[44:47], s37 offen offset:16
    s_endpgm
ka_stats:
    s_sub_u32 s28, s2, 144
    s_lshl_b32 s29, s28, 5
    s_lshl_b32 s28, s28, 4
    s_add_u32 s28, s28, 256
    s_cmp_lt_u32 s2, 160
    s_cselect_b32 s28, s29, s28
    s_cselect_b32 s29, 32, 16
    v_lshrrev_b32 v1, 4, v0
    v_cmp_gt_u32 vcc, s29, v1
    v_add_u32 v1, s28, v1
    v_mov_b32 v2, 0x100000
    v_cndmask_b32 v1, v2, v1, vcc
    v_and_b32 v2, 15, v0
    s_movk_i32 s29, 1152
    v_mul_lo_u32 v3, v1, s29
    v_lshl_add_u32 v3, v2, 3, v3
    v_lshlrev_b32 v4, 3, v1
    s_waitcnt lgkmcnt(0)

    s_mov_b32 s40, s38
    s_mov_b32 s41, s39
    s_mov_b32 s42, 0x240000
    s_mov_b32 s43, 0x00020000
    s_add_u32 s44, s26, 0x2f40000
    s_addc_u32 s45, s27, 0
    s_mov_b32 s46, 0x8000
    s_mov_b32 s47, 0x00020000
    s_mov_b32 s52, s50
    s_mov_b32 s53, s51
    s_mov_b32 s54, 0x100
    s_mov_b32 s55, 0x00020000
    s_mov_b32 s33, 0
    buffer_load_dwordx2 v[72:73], v3, s[40:43], s33 offen offset:0
    buffer_load_dwordx2 v[74:75], v3, s[40:43], s33 offen offset:128
    buffer_load_dwordx2 v[76:77], v3, s[40:43], s33 offen offset:256
    buffer_load_dwordx2 v[78:79], v3, s[40:43], s33 offen offset:384
    buffer_load_dwordx2 v[80:81], v3, s[40:43], s33 offen offset:512
    buffer_load_dwordx2 v[82:83], v3, s[40:43], s33 offen offset:640
    buffer_load_dwordx2 v[84:85], v3, s[40:43], s33 offen offset:768
    buffer_load_dwordx2 v[86:87], v3, s[40:43], s33 offen offset:896
    buffer_load_dwordx2 v[88:89], v3, s[40:43], s33 offen offset:1024
    s_mov_b32 s30, 0xffff0000
    s_mov_b32 s31, 0x3ae38e39
    s_mov_b32 s32, 0x3727c5ac
    v_cmp_eq_u32 s[36:37], 0, v2
    s_movk_i32 s33, 16384
    v_mov_b32 v14, -1
    v_mov_b32 v15, -1
    s_waitcnt vmcnt(0)
    v_lshlrev_b32 v34, 16, v72
    v_and_b32 v35, s30, v72
    v_lshlrev_b32 v36, 16, v73
    v_and_b32 v37, s30, v73
    v_lshlrev_b32 v38, 16, v74
    v_and_b32 v39, s30, v74
    v_lshlrev_b32 v40, 16, v75
    v_and_b32 v41, s30, v75
    v_lshlrev_b32 v42, 16, v76
    v_and_b32 v43, s30, v76
    v_lshlrev_b32 v44, 16, v77
    v_and_b32 v45, s30, v77
    v_lshlrev_b32 v46, 16, v78
    v_and_b32 v47, s30, v78
    v_lshlrev_b32 v48, 16, v79
    v_and_b32 v49, s30, v79
    v_lshlrev_b32 v50, 16, v80
    v_and_b32 v51, s30, v80
    v_lshlrev_b32 v52, 16, v81
    v_and_b32 v53, s30, v81
    v_lshlrev_b32 v54, 16, v82
    v_and_b32 v55, s30, v82
    v_lshlrev_b32 v56, 16, v83
    v_and_b32 v57, s30, v83
    v_lshlrev_b32 v58, 16, v84
    v_and_b32 v59, s30, v84
    v_lshlrev_b32 v60, 16, v85
    v_and_b32 v61, s30, v85
    v_lshlrev_b32 v62, 16, v86
    v_and_b32 v63, s30, v86
    v_lshlrev_b32 v64, 16, v87
    v_and_b32 v65, s30, v87
    v_lshlrev_b32 v66, 16, v88
    v_and_b32 v67, s30, v88
    v_lshlrev_b32 v68, 16, v89
    v_and_b32 v69, s30, v89
    v_pk_add_f32 v[8:9], v[34:35], v[36:37]
    v_pk_add_f32 v[10:11], v[38:39], v[40:41]
    v_pk_add_f32 v[8:9], v[8:9], v[42:43]
    v_pk_add_f32 v[10:11], v[10:11], v[44:45]
    v_pk_add_f32 v[8:9], v[8:9], v[46:47]
    v_pk_add_f32 v[10:11], v[10:11], v[48:49]
    v_pk_add_f32 v[8:9], v[8:9], v[50:51]
    v_pk_add_f32 v[10:11], v[10:11], v[52:53]
    v_pk_add_f32 v[8:9], v[8:9], v[54:55]
    v_pk_add_f32 v[10:11], v[10:11], v[56:57]
    v_pk_add_f32 v[8:9], v[8:9], v[58:59]
    v_pk_add_f32 v[10:11], v[10:11], v[60:61]
    v_pk_add_f32 v[8:9], v[8:9], v[62:63]
    v_pk_add_f32 v[10:11], v[10:11], v[64:65]
    v_pk_add_f32 v[8:9], v[8:9], v[66:67]
    v_pk_add_f32 v[10:11], v[10:11], v[68:69]
    v_pk_add_f32 v[8:9], v[8:9], v[10:11]
    v_add_f32 v8, v8, v9
    s_nop 1
    v_add_f32_dpp v8, v8, v8 row_ror:8 row_mask:0xf bank_mask:0xf
    s_nop 1
    v_add_f32_dpp v8, v8, v8 row_ror:4 row_mask:0xf bank_mask:0xf
    s_nop 1
    v_add_f32_dpp v8, v8, v8 row_ror:2 row_mask:0xf bank_mask:0xf
    s_nop 1
    v_add_f32_dpp v8, v8, v8 row_ror:1 row_mask:0xf bank_mask:0xf
    v_mul_f32 v8, s31, v8
    v_pk_add_f32 v[34:35], v[34:35], v[8:9] op_sel_hi:[1,0] neg_lo:[0,1] neg_hi:[0,1]
    v_pk_add_f32 v[36:37], v[36:37], v[8:9] op_sel_hi:[1,0] neg_lo:[0,1] neg_hi:[0,1]
    v_pk_add_f32 v[38:39], v[38:39], v[8:9] op_sel_hi:[1,0] neg_lo:[0,1] neg_hi:[0,1]
    v_pk_add_f32 v[40:41], v[40:41], v[8:9] op_sel_hi:[1,0] neg_lo:[0,1] neg_hi:[0,1]
    v_pk_add_f32 v[42:43], v[42:43], v[8:9] op_sel_hi:[1,0] neg_lo:[0,1] neg_hi:[0,1]
    v_pk_add_f32 v[44:45], v[44:45], v[8:9] op_sel_hi:[1,0] neg_lo:[0,1] neg_hi:[0,1]
    v_pk_add_f32 v[46:47], v[46:47], v[8:9] op_sel_hi:[1,0] neg_lo:[0,1] neg_hi:[0,1]
    v_pk_add_f32 v[48:49], v[48:49], v[8:9] op_sel_hi:[1,0] neg_lo:[0,1] neg_hi:[0,1]
    v_pk_add_f32 v[50:51], v[50:51], v[8:9] op_sel_hi:[1,0] neg_lo:[0,1] neg_hi:[0,1]
    v_pk_add_f32 v[52:53], v[52:53], v[8:9] op_sel_hi:[1,0] neg_lo:[0,1] neg_hi:[0,1]
    v_pk_add_f32 v[54:55], v[54:55], v[8:9] op_sel_hi:[1,0] neg_lo:[0,1] neg_hi:[0,1]
    v_pk_add_f32 v[56:57], v[56:57], v[8:9] op_sel_hi:[1,0] neg_lo:[0,1] neg_hi:[0,1]
    v_pk_add_f32 v[58:59], v[58:59], v[8:9] op_sel_hi:[1,0] neg_lo:[0,1] neg_hi:[0,1]
    v_pk_add_f32 v[60:61], v[60:61], v[8:9] op_sel_hi:[1,0] neg_lo:[0,1] neg_hi:[0,1]
    v_pk_add_f32 v[62:63], v[62:63], v[8:9] op_sel_hi:[1,0] neg_lo:[0,1] neg_hi:[0,1]
    v_pk_add_f32 v[64:65], v[64:65], v[8:9] op_sel_hi:[1,0] neg_lo:[0,1] neg_hi:[0,1]
    v_pk_add_f32 v[66:67], v[66:67], v[8:9] op_sel_hi:[1,0] neg_lo:[0,1] neg_hi:[0,1]
    v_pk_add_f32 v[68:69], v[68:69], v[8:9] op_sel_hi:[1,0] neg_lo:[0,1] neg_hi:[0,1]
    v_pk_mul_f32 v[10:11], v[34:35], v[34:35]
    v_pk_mul_f32 v[12:13], v[36:37], v[36:37]
    v_pk_fma_f32 v[10:11], v[38:39], v[38:39], v[10:11]
    v_pk_fma_f32 v[12:13], v[40:41], v[40:41], v[12:13]
    v_pk_fma_f32 v[10:11], v[42:43], v[42:43], v[10:11]
    v_pk_fma_f32 v[12:13], v[44:45], v[44:45], v[12:13]
    v_pk_fma_f32 v[10:11], v[46:47], v[46:47], v[10:11]
    v_pk_fma_f32 v[12:13], v[48:49], v[48:49], v[12:13]
    v_pk_fma_f32 v[10:11], v[50:51], v[50:51], v[10:11]
    v_pk_fma_f32 v[12:13], v[52:53], v[52:53], v[12:13]
    v_pk_fma_f32 v[10:11], v[54:55], v[54:55], v[10:11]
    v_pk_fma_f32 v[12:13], v[56:57], v[56:57], v[12:13]
    v_pk_fma_f32 v[10:11], v[58:59], v[58:59], v[10:11]
    v_pk_fma_f32 v[12:13], v[60:61], v[60:61], v[12:13]
    v_pk_fma_f32 v[10:11], v[62:63], v[62:63], v[10:11]
    v_pk_fma_f32 v[12:13], v[64:65], v[64:65], v[12:13]
    v_pk_fma_f32 v[10:11], v[66:67], v[66:67], v[10:11]
    v_pk_fma_f32 v[12:13], v[68:69], v[68:69], v[12:13]
    v_pk_add_f32 v[10:11], v[10:11], v[12:13]
    v_add_f32 v9, v10, v11
    s_nop 1
    v_add_f32_dpp v9, v9, v9 row_ror:8 row_mask:0xf bank_mask:0xf
    s_nop 1
    v_add_f32_dpp v9, v9, v9 row_ror:4 row_mask:0xf bank_mask:0xf
    s_nop 1
    v_add_f32_dpp v9, v9, v9 row_ror:2 row_mask:0xf bank_mask:0xf
    s_nop 1
    v_add_f32_dpp v9, v9, v9 row_ror:1 row_mask:0xf bank_mask:0xf
    v_mov_b32 v10, s32
    v_fmac_f32 v10, s31, v9
    v_rsq_f32 v9, v10
    s_mov_b64 exec, s[36:37]
    buffer_store_dwordx2 v[8:9], v4, s[44:47], 0 offen offset:0 sc1
    buffer_store_dwordx2 v[14:15], v4, s[44:47], s33 offen offset:0
    s_mov_b64 exec, -1

    v_mov_b32 v13, 1
    v_mov_b32 v12, s2
    s_waitcnt vmcnt(0)
    s_barrier
    v_cmp_eq_u32 vcc, 0, v0
    s_and_saveexec_b64 s[34:35], vcc
    s_cbranch_execz ka_nf
    buffer_store_byte v13, v12, s[52:55], 0 offen sc1

ka_nf:
    s_mov_b64 exec, s[34:35]
    s_cmp_ge_u32 s2, 160
    s_cbranch_scc1 ka_pack0
    s_endpgm
ka_pack0:
    s_sub_u32 s2, s2, 160
    s_load_dwordx4 s[4:7], s[0:1], 56
    v_lshrrev_b32 v1, 6, v0
    v_and_b32 v2, 63, v0
    v_lshlrev_b32 v3, 4, v2
    v_readfirstlane_b32 s28, v1

    v_and_b32 v0, 255, v0
    s_lshr_b32 s29, s28, 2
    s_and_b32 s28, s28, 3
    s_mul_i32 s48, s29, 55296

    s_mul_i32 s49, s29, 3
    s_cmp_ge_u32 s2, 48
    s_cselect_b32 s30, 1, 0
    s_mul_i32 s31, s30, 48
    s_sub_u32 s31, s2, s31
    s_movk_i32 s34, 5462
    s_movk_i32 s35, 9216

    v_add_u32 v4, 0, v0
    v_mul_lo_u32 v5, v4, s34
    v_lshrrev_b32 v5, 16, v5
    v_mul_u32_u24 v6, 12, v5
    v_sub_u32 v6, v4, v6
    v_mul_lo_u32 v5, v5, s35
    v_lshl_add_u32 v10, v6, 4, v5
    v_add_u32 v4, 256, v0
    v_mul_lo_u32 v5, v4, s34
    v_lshrrev_b32 v5, 16, v5
    v_mul_u32_u24 v6, 12, v5
    v_sub_u32 v6, v4, v6
    v_mul_lo_u32 v5, v5, s35
    v_lshl_add_u32 v11, v6, 4, v5
    v_add_u32 v4, 512, v0
    v_mul_lo_u32 v5, v4, s34
    v_lshrrev_b32 v5, 16, v5
    v_mul_u32_u24 v6, 12, v5
    v_sub_u32 v6, v4, v6
    v_mul_lo_u32 v5, v5, s35
    v_lshl_add_u32 v12, v6, 4, v5
    v_add_u32 v4, 768, v0
    v_mul_lo_u32 v5, v4, s34
    v_lshrrev_b32 v5, 16, v5
    v_mul_u32_u24 v6, 12, v5
    v_sub_u32 v6, v4, v6
    v_mul_lo_u32 v5, v5, s35
    v_lshl_add_u32 v13, v6, 4, v5
    v_add_u32 v4, 1024, v0
    v_mul_lo_u32 v5, v4, s34
    v_lshrrev_b32 v5, 16, v5
    v_mul_u32_u24 v6, 12, v5
    v_sub_u32 v6, v4, v6
    v_mul_lo_u32 v5, v5, s35
    v_lshl_add_u32 v14, v6, 4, v5
    s_mul_i32 s32, s31, 192
    s_add_u32 s32, s32, 0
    s_mul_i32 s33, s49, 884736
    s_add_u32 s32, s32, s33
    s_lshl_b32 s33, s28, 10
    s_add_u32 s33, s33, s48
    s_waitcnt lgkmcnt(0)
    s_cmp_eq_u32 s30, 0
    s_cselect_b32 s8, s4, s6
    s_cselect_b32 s9, s5, s7
    s_mov_b32 s10, 0x510000
    s_mov_b32 s11, 0x00020000

    s_add_u32 s12, s26, 0x2f48000
    s_addc_u32 s13, s27, 0
    s_mov_b32 s14, 0x36000
    s_mov_b32 s15, 0x00020000
    s_add_u32 s16, s26, 0x2f7e000
    s_addc_u32 s17, s27, 0
    s_mov_b32 s18, 0xa20000
    s_mov_b32 s19, 0x00020000
    s_cmp_ge_u32 s28, 2
    s_cbranch_scc1 ka0_sk_1
    s_add_u32 m0, s33, 16384
    s_nop 0
    buffer_load_dwordx4 v14, s[8:11], s32 offen lds
ka0_sk_1:
    s_add_u32 m0, s33, 0
    s_nop 0
    buffer_load_dwordx4 v10, s[8:11], s32 offen lds
    s_add_u32 m0, s33, 4096
    s_nop 0
    buffer_load_dwordx4 v11, s[8:11], s32 offen lds
    s_add_u32 m0, s33, 8192
    s_nop 0
    buffer_load_dwordx4 v12, s[8:11], s32 offen lds
    s_add_u32 m0, s33, 12288
    s_nop 0
    buffer_load_dwordx4 v13, s[8:11], s32 offen lds
    s_add_u32 s32, s32, 884736
    s_cmp_ge_u32 s28, 2
    s_cbranch_scc1 ka0_sk_2
    s_add_u32 m0, s33, 34816
    s_nop 0
    buffer_load_dwordx4 v14, s[8:11], s32 offen lds
ka0_sk_2:
    s_add_u32 m0, s33, 18432
    s_nop 0
    buffer_load_dwordx4 v10, s[8:11], s32 offen lds
    s_add_u32 m0, s33, 22528
    s_nop 0
    buffer_load_dwordx4 v11, s[8:11], s32 offen lds
    s_add_u32 m0, s33, 26624
    s_nop 0
    buffer_load_dwordx4 v12, s[8:11], s32 offen lds
    s_add_u32 m0, s33, 30720
    s_nop 0
    buffer_load_dwordx4 v13, s[8:11], s32 offen lds
    s_add_u32 s32, s32, 884736
    s_cmp_ge_u32 s28, 2
    s_cbranch_scc1 ka0_sk_3
    s_add_u32 m0, s33, 53248
    s_nop 0
    buffer_load_dwordx4 v14, s[8:11], s32 offen lds
ka0_sk_3:
    s_add_u32 m0, s33, 36864
    s_nop 0
    buffer_load_dwordx4 v10, s[8:11], s32 offen lds
    s_add_u32 m0, s33, 40960
    s_nop 0
    buffer_load_dwordx4 v11, s[8:11], s32 offen lds
    s_add_u32 m0, s33, 45056
    s_nop 0
    buffer_load_dwordx4 v12, s[8:11], s32 offen lds
    s_add_u32 m0, s33, 49152
    s_nop 0
    buffer_load_dwordx4 v13, s[8:11], s32 offen lds
    s_add_u32 s32, s32, 884736
    v_lshrrev_b32 v4, 4, v2
    v_lshlrev_b32 v4, 3, v4
    v_bfe_u32 v5, v2, 2, 2
    v_add_u32 v4, v4, v5
    v_mul_u32_u24 v4, 192, v4
    v_and_b32 v5, 3, v2
    v_lshl_add_u32 v4, v5, 3, v4
    v_add_u32 v4, s48, v4
    v_mov_b32 v7, 0x3f803f80
    v_lshlrev_b32 v9, 2, v2
    v_cmp_gt_u32 s[46:47], 16, v2
    s_mov_b32 s36, s28
    s_mov_b32 s45, 0

    s_waitcnt vmcnt(4)
    s_barrier
ka0_su0:
    s_mul_i32 s38, s36, 43
    s_lshr_b32 s38, s38, 8
    s_mul_i32 s37, s38, 6
    s_sub_u32 s37, s36, s37
    s_lshl_b32 s40, s37, 5
    s_mul_i32 s44, s38, 18432
    s_add_u32 s40, s40, s44
    v_add_u32 v5, s40, v4
    s_mul_i32 s39, s31, 6
    s_add_u32 s39, s39, s37

    ds_read_b64_tr_b16 v[16:17], v5 offset:0
    ds_read_b64_tr_b16 v[18:19], v5 offset:768
    ds_read_b64_tr_b16 v[20:21], v5 offset:6144
    ds_read_b64_tr_b16 v[22:23], v5 offset:6912
    ds_read_b64_tr_b16 v[24:25], v5 offset:12288
    ds_read_b64_tr_b16 v[26:27], v5 offset:13056
    s_mul_i32 s40, s39, 7282
    s_lshr_b32 s40, s40, 16
    s_mul_i32 s41, s40, 9
    s_sub_u32 s41, s39, s41
    s_cmp_lt_u32 s41, 3
    s_cselect_b32 s42, 2, 36
    s_cselect_b32 s43, 6, 2
    s_lshl_b32 s43, s43, 10
    s_mul_i32 s42, s42, s41
    s_mul_i32 s40, s40, 324
    s_add_u32 s42, s42, s40
    s_add_u32 s42, s42, s30
    s_lshl_b32 s42, s42, 10
    s_add_u32 s44, s38, 0
    s_add_u32 s44, s44, s49
    s_mul_i32 s40, s44, 3
    s_mul_i32 s40, s40, s43
    s_add_u32 s42, s42, s40
    s_lshl_b32 s44, s44, 1
    s_add_u32 s44, s44, s30
    s_mul_i32 s44, s44, 18432
    s_lshl_b32 s40, s39, 6
    s_add_u32 s44, s44, s40
    v_mov_b32 v6, 0

    s_waitcnt lgkmcnt(4)
    buffer_store_dwordx4 v[16:19], v3, s[16:19], s42 offen sc1
    s_add_u32 s42, s42, s43
    v_dot2_f32_bf16 v6, v16, v7, v6
    v_dot2_f32_bf16 v6, v17, v7, v6
    v_dot2_f32_bf16 v6, v18, v7, v6
    v_dot2_f32_bf16 v6, v19, v7, v6
    s_waitcnt lgkmcnt(2)
    buffer_store_dwordx4 v[20:23], v3, s[16:19], s42 offen sc1
    s_add_u32 s42, s42, s43
    v_dot2_f32_bf16 v6, v20, v7, v6
    v_dot2_f32_bf16 v6, v21, v7, v6
    v_dot2_f32_bf16 v6, v22, v7, v6
    v_dot2_f32_bf16 v6, v23, v7, v6
    s_waitcnt lgkmcnt(0)
    buffer_store_dwordx4 v[24:27], v3, s[16:19], s42 offen sc1
    s_add_u32 s42, s42, s43
    v_dot2_f32_bf16 v6, v24, v7, v6
    v_dot2_f32_bf16 v6, v25, v7, v6
    v_dot2_f32_bf16 v6, v26, v7, v6
    v_dot2_f32_bf16 v6, v27, v7, v6
    s_nop 2
    v_mov_b32 v8, v6
    s_nop 1
    v_permlane32_swap_b32 v6, v8
    v_add_f32 v6, v6, v8
    v_mov_b32 v8, v6
    s_nop 1
    v_permlane16_swap_b32 v6, v8
    v_add_f32 v6, v6, v8
    s_mov_b64 exec, s[46:47]
    buffer_store_dword v6, v9, s[12:15], s44 offen
    s_mov_b64 exec, -1
    s_add_u32 s36, s36, 4
    s_cmp_lt_u32 s36, 12
    s_cbranch_scc1 ka0_su0

    s_waitcnt vmcnt(12)
    s_barrier
ka0_su1:
    s_mul_i32 s38, s36, 43
    s_lshr_b32 s38, s38, 8
    s_mul_i32 s37, s38, 6
    s_sub_u32 s37, s36, s37
    s_lshl_b32 s40, s37, 5
    s_mul_i32 s44, s38, 18432
    s_add_u32 s40, s40, s44
    v_add_u32 v5, s40, v4
    s_mul_i32 s39, s31, 6
    s_add_u32 s39, s39, s37

    ds_read_b64_tr_b16 v[16:17], v5 offset:0
    ds_read_b64_tr_b16 v[18:19], v5 offset:768
    ds_read_b64_tr_b16 v[20:21], v5 offset:6144
    ds_read_b64_tr_b16 v[22:23], v5 offset:6912
    ds_read_b64_tr_b16 v[24:25], v5 offset:12288
    ds_read_b64_tr_b16 v[26:27], v5 offset:13056
    s_mul_i32 s40, s39, 7282
    s_lshr_b32 s40, s40, 16
    s_mul_i32 s41, s40, 9
    s_sub_u32 s41, s39, s41
    s_cmp_lt_u32 s41, 3
    s_cselect_b32 s42, 2, 36
    s_cselect_b32 s43, 6, 2
    s_lshl_b32 s43, s43, 10
    s_mul_i32 s42, s42, s41
    s_mul_i32 s40, s40, 324
    s_add_u32 s42, s42, s40
    s_add_u32 s42, s42, s30
    s_lshl_b32 s42, s42, 10
    s_add_u32 s44, s38, 0
    s_add_u32 s44, s44, s49
    s_mul_i32 s40, s44, 3
    s_mul_i32 s40, s40, s43
    s_add_u32 s42, s42, s40
    s_lshl_b32 s44, s44, 1
    s_add_u32 s44, s44, s30
    s_mul_i32 s44, s44, 18432
    s_lshl_b32 s40, s39, 6
    s_add_u32 s44, s44, s40
    v_mov_b32 v6, 0

    s_waitcnt lgkmcnt(4)
    buffer_store_dwordx4 v[16:19], v3, s[16:19], s42 offen sc1
    s_add_u32 s42, s42, s43
    v_dot2_f32_bf16 v6, v16, v7, v6
    v_dot2_f32_bf16 v6, v17, v7, v6
    v_dot2_f32_bf16 v6, v18, v7, v6
    v_dot2_f32_bf16 v6, v19, v7, v6
    s_waitcnt lgkmcnt(2)
    buffer_store_dwordx4 v[20:23], v3, s[16:19], s42 offen sc1
    s_add_u32 s42, s42, s43
    v_dot2_f32_bf16 v6, v20, v7, v6
    v_dot2_f32_bf16 v6, v21, v7, v6
    v_dot2_f32_bf16 v6, v22, v7, v6
    v_dot2_f32_bf16 v6, v23, v7, v6
    s_waitcnt lgkmcnt(0)
    buffer_store_dwordx4 v[24:27], v3, s[16:19], s42 offen sc1
    s_add_u32 s42, s42, s43
    v_dot2_f32_bf16 v6, v24, v7, v6
    v_dot2_f32_bf16 v6, v25, v7, v6
    v_dot2_f32_bf16 v6, v26, v7, v6
    v_dot2_f32_bf16 v6, v27, v7, v6
    s_nop 2
    v_mov_b32 v8, v6
    s_nop 1
    v_permlane32_swap_b32 v6, v8
    v_add_f32 v6, v6, v8
    v_mov_b32 v8, v6
    s_nop 1
    v_permlane16_swap_b32 v6, v8
    v_add_f32 v6, v6, v8
    s_mov_b64 exec, s[46:47]
    buffer_store_dword v6, v9, s[12:15], s44 offen
    s_mov_b64 exec, -1
    s_add_u32 s36, s36, 4
    s_cmp_lt_u32 s36, 18
    s_cbranch_scc1 ka0_su1

ka_done:
    s_endpgm
.globl kc_kernel
.p2align 8
.type kc_kernel,@function
kc_kernel:
    s_cmp_ge_u32 s2, 256
    s_cbranch_scc1 kc_done
    s_load_dwordx2 s[26:27], s[0:1], 96
    s_load_dwordx2 s[4:5], s[0:1], 72
    v_lshrrev_b32 v1, 6, v0
    v_and_b32 v2, 63, v0
    v_lshlrev_b32 v3, 4, v2
    v_readfirstlane_b32 s28, v1
    s_and_b32 s33, s2, 7
    s_lshr_b32 s34, s2, 3
    s_lshr_b32 s29, s33, 1
    s_lshl_b32 s29, s29, 3
    s_and_b32 s31, s34, 7
    s_add_u32 s29, s29, s31
    s_and_b32 s30, s33, 1
    s_lshl_b32 s30, s30, 2
    s_lshr_b32 s31, s34, 3
    s_add_u32 s30, s30, s31
    s_lshl_b32 s33, s30, 8
    s_lshl_b32 s34, s28, 5
    s_add_u32 s33, s33, s34
    v_and_b32 v4, 15, v2
    v_add_u32 v4, s33, v4
    v_lshrrev_b32 v5, 4, v2
    v_lshlrev_b32 v5, 15, v5
    v_lshl_add_u32 v9, v4, 4, v5
    s_lshl_b32 s36, s28, 12
    s_mul_i32 s37, s29, 331776
    s_lshl_b32 s31, s28, 10
    s_add_u32 s31, s31, 32768
    s_and_b32 s64, s29, 0
    s_mul_i32 s65, s64, 12288
    s_add_u32 s66, s65, s36
    s_add_u32 s67, s65, s31
    s_lshl_b32 s65, s64, 12
    s_add_u32 s68, s65, s36
    s_add_u32 s69, s65, s31
    s_sub_u32 s65, s68, 36864
    s_cmp_ge_u32 s68, 36864
    s_cselect_b32 s68, s65, s68
    s_sub_u32 s65, s69, 36864
    s_cmp_ge_u32 s69, 36864
    s_cselect_b32 s69, s65, s69
    s_add_u32 s68, s68, s37
    s_add_u32 s69, s69, s37
    s_lshl_b32 s70, s64, 18
    s_waitcnt lgkmcnt(0)

    s_add_u32 s8, s26, 0x2f7e000
    s_addc_u32 s9, s27, 0
    s_mov_b32 s10, 0xa20000
    s_mov_b32 s11, 0x00020000
    s_add_u32 s12, s26, 0x900000
    s_addc_u32 s13, s27, 0
    s_mov_b32 s14, 0x240000
    s_mov_b32 s15, 0x00020000
    s_cmp_ge_u32 s28, 4
    s_cbranch_scc1 kc_skip_4
    s_add_u32 m0, s31, 0
    s_add_u32 s38, s67, 0
    s_sub_u32 s65, s38, 110592
    s_cmp_ge_u32 s38, 110592
    s_cselect_b32 s38, s65, s38
    s_add_u32 s38, s38, s37
    buffer_load_dwordx4 v3, s[8:11], s38 offen lds
kc_skip_4:
    s_add_u32 m0, s36, 0
    s_add_u32 s38, s66, 0
    s_sub_u32 s65, s38, 110592
    s_cmp_ge_u32 s38, 110592
    s_cselect_b32 s38, s65, s38
    s_add_u32 s38, s38, s37
    buffer_load_dwordx4 v3, s[8:11], s38 offen offset:0 lds
    buffer_load_dwordx4 v3, s[8:11], s38 offen offset:1024 lds
    buffer_load_dwordx4 v3, s[8:11], s38 offen offset:2048 lds
    buffer_load_dwordx4 v3, s[8:11], s38 offen offset:3072 lds
    s_mov_b32 s40, s70
    s_add_u32 s70, s70, 0x20000
    s_cmp_ge_u32 s70, 0x240000
    s_cselect_b32 s70, 0, s70
    buffer_load_dwordx4 v[112:115], v9, s[12:15], s40 offen offset:0
    buffer_load_dwordx4 v[116:119], v9, s[12:15], s40 offen offset:256
    s_mov_b32 s40, s70
    s_add_u32 s70, s70, 0x20000
    s_cmp_ge_u32 s70, 0x240000
    s_cselect_b32 s70, 0, s70
    buffer_load_dwordx4 v[120:123], v9, s[12:15], s40 offen offset:0
    buffer_load_dwordx4 v[124:127], v9, s[12:15], s40 offen offset:256
    s_add_u32 s48, s26, 0x2f44000
    s_addc_u32 s49, s27, 0
    s_mov_b32 s50, 0x4000
    s_mov_b32 s51, 0x00020000
    s_lshl_b32 s52, s30, 8
    s_lshl_b32 s53, s29, 3
    s_add_u32 s52, s52, s53
    s_add_u32 s52, s52, s28
    s_lshl_b32 s53, s52, 4
    s_add_u32 s54, s53, 1179648
    v_lshlrev_b32 v4, 15, v2
    v_mov_b32 v5, 0x7ffffff0
    v_cmp_gt_u32 s[56:57], 36, v2
    s_lshl_b32 s52, s52, 3
    s_nop 0
    v_cndmask_b32 v4, v5, v4, s[56:57]
    buffer_load_dwordx4 v[24:27], v4, s[12:15], s53 offen
    buffer_load_dwordx4 v[28:31], v4, s[12:15], s54 offen

    s_add_u32 s16, s26, 0xb40000
    s_addc_u32 s17, s27, 0
    s_mov_b32 s18, 0x1200000
    s_mov_b32 s19, 0x00020000
    s_add_u32 s20, s26, 0x2f48000
    s_addc_u32 s21, s27, 0
    s_mov_b32 s22, 0x36000
    s_mov_b32 s23, 0x00020000
    v_and_b32 v4, 31, v2
    v_add_u32 v4, s33, v4
    v_lshrrev_b32 v5, 5, v2
    v_lshlrev_b32 v5, 15, v5
    v_lshl_add_u32 v1, v4, 4, v5
    v_add_u32 v6, 36864, v3
    v_add_u32 v7, 73728, v3
    v_add_u32 v8, 110592, v3
    v_lshrrev_b32 v10, 4, v2
    v_lshlrev_b32 v10, 4, v10
    v_add_u32 v10, 147456, v10
    s_lshr_b32 s32, s28, 2
    s_mul_i32 s33, s32, 18432
    s_mul_i32 s34, s29, 576
    s_add_u32 s33, s33, s34
    v_mov_b32 v5, 0x7ffffff0
    v_cmp_gt_u32 vcc, 36, v2
    s_lshl_b32 s32, s32, 10
    s_add_u32 s32, s32, 147456
    v_cndmask_b32 v13, v5, v3, vcc
    v_add_u32 v11, s32, v3
    s_mov_b32 s55, s33
    s_mov_b32 s47, 0xffff0000
    s_mul_i32 s42, s29, 589824

    s_mov_b32 s44, 0x3ae38e39
    v_and_b32 v12, 0x7fff, v9
    v_lshrrev_b32 v12, 1, v12

    s_waitcnt vmcnt(6)
    s_barrier
    ds_read_b128 v[40:43], v3 offset:0
    ds_read_b128 v[44:47], v3 offset:1024
    ds_read_b128 v[48:51], v3 offset:2048
    ds_read_b128 v[52:55], v3 offset:3072
    ds_read_b128 v[56:59], v3 offset:4096
    s_waitcnt vmcnt(4)
    s_waitcnt lgkmcnt(3)
    v_mfma_f32_16x16x32_bf16 v[64:67], v[40:43], v[112:115], 0
    ds_read_b128 v[60:63], v3 offset:5120
    s_mov_b32 s40, s70
    s_add_u32 s70, s70, 0x20000
    s_cmp_ge_u32 s70, 0x240000
    s_cselect_b32 s70, 0, s70
    v_mfma_f32_16x16x32_bf16 v[68:71], v[40:43], v[116:119], 0
    buffer_load_dwordx4 v[128:131], v9, s[12:15], s40 offen offset:0
    v_mfma_f32_16x16x32_bf16 v[72:75], v[44:47], v[112:115], 0
    ds_read_b128 v[40:43], v3 offset:6144
    buffer_load_dwordx4 v[132:135], v9, s[12:15], s40 offen offset:256
    v_mfma_f32_16x16x32_bf16 v[76:79], v[44:47], v[116:119], 0
    s_mov_b32 s40, s70
    s_add_u32 s70, s70, 0x20000
    s_cmp_ge_u32 s70, 0x240000
    s_cselect_b32 s70, 0, s70
    s_waitcnt lgkmcnt(3)
    v_mfma_f32_16x16x32_bf16 v[80:83], v[48:51], v[112:115], 0
    ds_read_b128 v[44:47], v3 offset:7168
    buffer_load_dwordx4 v[136:139], v9, s[12:15], s40 offen offset:0
    v_mfma_f32_16x16x32_bf16 v[84:87], v[48:51], v[116:119], 0
    buffer_load_dwordx4 v[140:143], v9, s[12:15], s40 offen offset:256
    v_mfma_f32_16x16x32_bf16 v[88:91], v[52:55], v[112:115], 0
    ds_read_b128 v[48:51], v3 offset:8192
    s_mov_b32 s40, s70
    s_add_u32 s70, s70, 0x20000
    s_cmp_ge_u32 s70, 0x240000
    s_cselect_b32 s70, 0, s70
    v_mfma_f32_16x16x32_bf16 v[92:95], v[52:55], v[116:119], 0
    buffer_load_dwordx4 v[144:147], v9, s[12:15], s40 offen offset:0
    s_waitcnt lgkmcnt(3)
    v_mfma_f32_16x16x32_bf16 v[96:99], v[56:59], v[112:115], 0
    ds_read_b128 v[52:55], v3 offset:9216
    buffer_load_dwordx4 v[148:151], v9, s[12:15], s40 offen offset:256
    s_waitcnt vmcnt(6)
    v_lshlrev_b32 v20, 16, v24
    v_mfma_f32_16x16x32_bf16 v[100:103], v[56:59], v[116:119], 0
    s_cmp_ge_u32 s28, 4
    s_cbranch_scc1 kc_skip_5
    s_add_u32 m0, s31, 36864
    s_add_u32 s38, s67, 36864
    s_sub_u32 s65, s38, 110592
    s_cmp_ge_u32 s38, 110592
    s_cselect_b32 s38, s65, s38
    s_add_u32 s38, s38, s37
    buffer_load_dwordx4 v3, s[8:11], s38 offen lds
kc_skip_5:
    v_and_b32 v21, s47, v24
    v_add_f32 v16, v20, v21
    v_mfma_f32_16x16x32_bf16 v[104:107], v[60:63], v[112:115], 0
    ds_read_b128 v[56:59], v3 offset:10240
    s_add_u32 m0, s36, 36864
    v_lshlrev_b32 v22, 16, v25
    v_and_b32 v23, s47, v25
    v_mfma_f32_16x16x32_bf16 v[108:111], v[60:63], v[116:119], 0
    s_add_u32 s38, s66, 36864
    s_sub_u32 s65, s38, 110592
    s_cmp_ge_u32 s38, 110592
    s_cselect_b32 s38, s65, s38
    s_add_u32 s38, s38, s37
    v_add_f32 v16, v16, v22
    v_add_f32 v16, v16, v23
    s_waitcnt lgkmcnt(3)
    v_mfma_f32_16x16x32_bf16 v[64:67], v[40:43], v[120:123], v[64:67]
    ds_read_b128 v[60:63], v3 offset:11264
    s_mov_b32 s40, s70
    s_add_u32 s70, s70, 0x20000
    s_cmp_ge_u32 s70, 0x240000
    s_cselect_b32 s70, 0, s70
    v_lshlrev_b32 v20, 16, v26
    v_and_b32 v21, s47, v26
    v_mfma_f32_16x16x32_bf16 v[68:71], v[40:43], v[124:127], v[68:71]
    buffer_load_dwordx4 v[152:155], v9, s[12:15], s40 offen offset:0
    v_add_f32 v16, v16, v20
    v_add_f32 v16, v16, v21
    v_mfma_f32_16x16x32_bf16 v[72:75], v[44:47], v[120:123], v[72:75]
    ds_read_b128 v[40:43], v3 offset:12288
    buffer_load_dwordx4 v[156:159], v9, s[12:15], s40 offen offset:256
    v_lshlrev_b32 v22, 16, v27
    v_and_b32 v23, s47, v27
    v_mfma_f32_16x16x32_bf16 v[76:79], v[44:47], v[124:127], v[76:79]
    buffer_load_dwordx4 v3, s[8:11], s38 offen offset:0 lds
    v_add_f32 v16, v16, v22
    v_add_f32 v16, v16, v23
    s_waitcnt lgkmcnt(3)
    v_mfma_f32_16x16x32_bf16 v[80:83], v[48:51], v[120:123], v[80:83]
    ds_read_b128 v[44:47], v3 offset:13312
    buffer_load_dwordx4 v3, s[8:11], s38 offen offset:1024 lds
    v_lshlrev_b32 v20, 16, v28
    v_and_b32 v21, s47, v28
    v_mfma_f32_16x16x32_bf16 v[84:87], v[48:51], v[124:127], v[84:87]
    buffer_load_dwordx4 v3, s[8:11], s38 offen offset:2048 lds
    v_add_f32 v16, v16, v20
    v_add_f32 v16, v16, v21
    v_mfma_f32_16x16x32_bf16 v[88:91], v[52:55], v[120:123], v[88:91]
    ds_read_b128 v[48:51], v3 offset:14336
    buffer_load_dwordx4 v3, s[8:11], s38 offen offset:3072 lds
    v_lshlrev_b32 v22, 16, v29
    v_and_b32 v23, s47, v29
    v_mfma_f32_16x16x32_bf16 v[92:95], v[52:55], v[124:127], v[92:95]
    v_add_f32 v16, v16, v22
    v_add_f32 v16, v16, v23
    s_waitcnt lgkmcnt(3)
    v_mfma_f32_16x16x32_bf16 v[96:99], v[56:59], v[120:123], v[96:99]
    ds_read_b128 v[52:55], v3 offset:15360
    v_lshlrev_b32 v20, 16, v30
    v_and_b32 v21, s47, v30
    v_mfma_f32_16x16x32_bf16 v[100:103], v[56:59], v[124:127], v[100:103]
    v_add_f32 v16, v16, v20
    v_add_f32 v16, v16, v21
    v_mfma_f32_16x16x32_bf16 v[104:107], v[60:63], v[120:123], v[104:107]
    ds_read_b128 v[56:59], v3 offset:16384
    v_lshlrev_b32 v22, 16, v31
    v_and_b32 v23, s47, v31
    v_mfma_f32_16x16x32_bf16 v[108:111], v[60:63], v[124:127], v[108:111]
    v_add_f32 v16, v16, v22
    v_add_f32 v16, v16, v23
    s_waitcnt vmcnt(10)
    s_waitcnt lgkmcnt(3)
    v_mfma_f32_16x16x32_bf16 v[64:67], v[40:43], v[128:131], v[64:67]
    ds_read_b128 v[60:63], v3 offset:17408
    s_nop 1
    v_add_f32_dpp v16, v16, v16 row_ror:8 row_mask:0xf bank_mask:0xf
    s_nop 1
    v_add_f32_dpp v16, v16, v16 row_ror:4 row_mask:0xf bank_mask:0xf
    v_mfma_f32_16x16x32_bf16 v[68:71], v[40:43], v[132:135], v[68:71]
    s_mov_b32 s40, s70
    s_add_u32 s70, s70, 0x20000
    s_cmp_ge_u32 s70, 0x240000
    s_cselect_b32 s70, 0, s70
    s_nop 1
    v_add_f32_dpp v16, v16, v16 row_ror:2 row_mask:0xf bank_mask:0xf
    s_nop 1
    v_add_f32_dpp v16, v16, v16 row_ror:1 row_mask:0xf bank_mask:0xf
    v_mfma_f32_16x16x32_bf16 v[72:75], v[44:47], v[128:131], v[72:75]
    ds_read_b128 v[40:43], v3 offset:18432
    v_mov_b32 v17, v16
    s_nop 1
    v_permlane16_swap_b32 v16, v17
    v_mfma_f32_16x16x32_bf16 v[76:79], v[44:47], v[132:135], v[76:79]
    buffer_load_dwordx4 v[160:163], v9, s[12:15], s40 offen offset:0
    v_add_f32 v16, v16, v17
    v_mov_b32 v17, v16
    s_waitcnt lgkmcnt(3)
    v_mfma_f32_16x16x32_bf16 v[80:83], v[48:51], v[128:131], v[80:83]
    ds_read_b128 v[44:47], v3 offset:19456
    s_nop 1
    v_permlane32_swap_b32 v16, v17
    v_add_f32 v16, v16, v17
    v_mfma_f32_16x16x32_bf16 v[84:87], v[48:51], v[132:135], v[84:87]
    buffer_load_dwordx4 v[164:167], v9, s[12:15], s40 offen offset:256
    v_mul_f32 v16, s44, v16
    v_mov_b32 v18, 0
    v_mfma_f32_16x16x32_bf16 v[88:91], v[52:55], v[128:131], v[88:91]
    ds_read_b128 v[48:51], v3 offset:20480
    v_lshlrev_b32 v20, 16, v24
    v_and_b32 v21, s47, v24
    v_mfma_f32_16x16x32_bf16 v[92:95], v[52:55], v[132:135], v[92:95]
    v_sub_f32 v20, v20, v16
    v_sub_f32 v21, v21, v16
    s_waitcnt lgkmcnt(3)
    v_mfma_f32_16x16x32_bf16 v[96:99], v[56:59], v[128:131], v[96:99]
    ds_read_b128 v[52:55], v3 offset:21504
    v_fmac_f32 v18, v20, v20
    v_fmac_f32 v18, v21, v21
    v_mfma_f32_16x16x32_bf16 v[100:103], v[56:59], v[132:135], v[100:103]
    v_lshlrev_b32 v22, 16, v25
    v_and_b32 v23, s47, v25
    v_mfma_f32_16x16x32_bf16 v[104:107], v[60:63], v[128:131], v[104:107]
    ds_read_b128 v[56:59], v3 offset:22528
    v_sub_f32 v22, v22, v16
    v_sub_f32 v23, v23, v16
    v_mfma_f32_16x16x32_bf16 v[108:111], v[60:63], v[132:135], v[108:111]
    v_fmac_f32 v18, v22, v22
    v_fmac_f32 v18, v23, v23
    s_waitcnt vmcnt(10)
    s_waitcnt lgkmcnt(3)
    v_mfma_f32_16x16x32_bf16 v[64:67], v[40:43], v[136:139], v[64:67]
    ds_read_b128 v[60:63], v3 offset:23552
    v_lshlrev_b32 v20, 16, v26
    v_and_b32 v21, s47, v26
    v_mfma_f32_16x16x32_bf16 v[68:71], v[40:43], v[140:143], v[68:71]
    s_mov_b32 s40, s70
    s_add_u32 s70, s70, 0x20000
    s_cmp_ge_u32 s70, 0x240000
    s_cselect_b32 s70, 0, s70
    v_sub_f32 v20, v20, v16
    v_sub_f32 v21, v21, v16
    v_mfma_f32_16x16x32_bf16 v[72:75], v[44:47], v[136:139], v[72:75]
    ds_read_b128 v[40:43], v3 offset:24576
    v_fmac_f32 v18, v20, v20
    v_fmac_f32 v18, v21, v21
    v_mfma_f32_16x16x32_bf16 v[76:79], v[44:47], v[140:143], v[76:79]
    buffer_load_dwordx4 v[168:171], v9, s[12:15], s40 offen offset:0
    v_lshlrev_b32 v22, 16, v27
    v_and_b32 v23, s47, v27
    s_waitcnt lgkmcnt(3)
    v_mfma_f32_16x16x32_bf16 v[80:83], v[48:51], v[136:139], v[80:83]
    ds_read_b128 v[44:47], v3 offset:25600
    v_sub_f32 v22, v22, v16
    v_sub_f32 v23, v23, v16
    v_mfma_f32_16x16x32_bf16 v[84:87], v[48:51], v[140:143], v[84:87]
    buffer_load_dwordx4 v[172:175], v9, s[12:15], s40 offen offset:256
    v_fmac_f32 v18, v22, v22
    v_fmac_f32 v18, v23, v23
    v_mfma_f32_16x16x32_bf16 v[88:91], v[52:55], v[136:139], v[88:91]
    ds_read_b128 v[48:51], v3 offset:26624
    v_lshlrev_b32 v20, 16, v28
    v_and_b32 v21, s47, v28
    v_mfma_f32_16x16x32_bf16 v[92:95], v[52:55], v[140:143], v[92:95]
    v_sub_f32 v20, v20, v16
    v_sub_f32 v21, v21, v16
    s_waitcnt lgkmcnt(3)
    v_mfma_f32_16x16x32_bf16 v[96:99], v[56:59], v[136:139], v[96:99]
    ds_read_b128 v[52:55], v3 offset:27648
    v_fmac_f32 v18, v20, v20
    v_fmac_f32 v18, v21, v21
    v_mfma_f32_16x16x32_bf16 v[100:103], v[56:59], v[140:143], v[100:103]
    v_lshlrev_b32 v22, 16, v29
    v_and_b32 v23, s47, v29
    v_mfma_f32_16x16x32_bf16 v[104:107], v[60:63], v[136:139], v[104:107]
    ds_read_b128 v[56:59], v3 offset:28672
    v_sub_f32 v22, v22, v16
    v_sub_f32 v23, v23, v16
    v_mfma_f32_16x16x32_bf16 v[108:111], v[60:63], v[140:143], v[108:111]
    v_fmac_f32 v18, v22, v22
    v_fmac_f32 v18, v23, v23
    s_waitcnt vmcnt(10)
    s_waitcnt lgkmcnt(3)
    v_mfma_f32_16x16x32_bf16 v[64:67], v[40:43], v[144:147], v[64:67]
    ds_read_b128 v[60:63], v3 offset:29696
    v_lshlrev_b32 v20, 16, v30
    v_and_b32 v21, s47, v30
    v_mfma_f32_16x16x32_bf16 v[68:71], v[40:43], v[148:151], v[68:71]
    s_mov_b32 s40, s70
    s_add_u32 s70, s70, 0x20000
    s_cmp_ge_u32 s70, 0x240000
    s_cselect_b32 s70, 0, s70
    v_sub_f32 v20, v20, v16
    v_sub_f32 v21, v21, v16
    v_mfma_f32_16x16x32_bf16 v[72:75], v[44:47], v[144:147], v[72:75]
    ds_read_b128 v[40:43], v3 offset:30720
    v_fmac_f32 v18, v20, v20
    v_fmac_f32 v18, v21, v21
    v_mfma_f32_16x16x32_bf16 v[76:79], v[44:47], v[148:151], v[76:79]
    buffer_load_dwordx4 v[176:179], v9, s[12:15], s40 offen offset:0
    v_lshlrev_b32 v22, 16, v31
    v_and_b32 v23, s47, v31
    s_waitcnt lgkmcnt(3)
    v_mfma_f32_16x16x32_bf16 v[80:83], v[48:51], v[144:147], v[80:83]
    ds_read_b128 v[44:47], v3 offset:31744
    v_sub_f32 v22, v22, v16
    v_sub_f32 v23, v23, v16
    v_mfma_f32_16x16x32_bf16 v[84:87], v[48:51], v[148:151], v[84:87]
    buffer_load_dwordx4 v[180:183], v9, s[12:15], s40 offen offset:256
    v_fmac_f32 v18, v22, v22
    v_fmac_f32 v18, v23, v23
    v_mfma_f32_16x16x32_bf16 v[88:91], v[52:55], v[144:147], v[88:91]
    ds_read_b128 v[48:51], v3 offset:32768
    v_cndmask_b32 v18, 0, v18, s[56:57]
    s_nop 1
    v_add_f32_dpp v18, v18, v18 row_ror:8 row_mask:0xf bank_mask:0xf
    v_mfma_f32_16x16x32_bf16 v[92:95], v[52:55], v[148:151], v[92:95]
    s_nop 1
    v_add_f32_dpp v18, v18, v18 row_ror:4 row_mask:0xf bank_mask:0xf
    s_nop 1
    v_add_f32_dpp v18, v18, v18 row_ror:2 row_mask:0xf bank_mask:0xf
    s_waitcnt lgkmcnt(3)
    v_mfma_f32_16x16x32_bf16 v[96:99], v[56:59], v[144:147], v[96:99]
    ds_read_b128 v[52:55], v3 offset:33792
    s_nop 1
    v_add_f32_dpp v18, v18, v18 row_ror:1 row_mask:0xf bank_mask:0xf
    v_mov_b32 v19, v18
    v_mfma_f32_16x16x32_bf16 v[100:103], v[56:59], v[148:151], v[100:103]
    s_nop 1
    v_permlane16_swap_b32 v18, v19
    v_add_f32 v18, v18, v19
    v_mfma_f32_16x16x32_bf16 v[104:107], v[60:63], v[144:147], v[104:107]
    ds_read_b128 v[56:59], v3 offset:34816
    v_mov_b32 v19, v18
    s_nop 1
    v_permlane32_swap_b32 v18, v19
    v_mfma_f32_16x16x32_bf16 v[108:111], v[60:63], v[148:151], v[108:111]
    v_add_f32 v18, v18, v19
    v_mov_b32 v17, 0x3727c5ac
    s_waitcnt vmcnt(10)
    s_waitcnt lgkmcnt(3)
    v_mfma_f32_16x16x32_bf16 v[64:67], v[40:43], v[152:155], v[64:67]
    ds_read_b128 v[60:63], v3 offset:35840
    v_fmac_f32 v17, s44, v18
    v_mov_b32 v4, 0
    v_mfma_f32_16x16x32_bf16 v[68:71], v[40:43], v[156:159], v[68:71]
    s_mov_b32 s40, s70
    s_add_u32 s70, s70, 0x20000
    s_cmp_ge_u32 s70, 0x240000
    s_cselect_b32 s70, 0, s70
    s_mov_b64 exec, 1
    buffer_store_dwordx2 v[16:17], v4, s[48:51], s52 offen sc1
    s_mov_b64 exec, -1
    buffer_load_dwordx4 v[32:35], v13, s[20:23], s55 offen
    s_add_u32 s55, s55, 36864
    v_mfma_f32_16x16x32_bf16 v[72:75], v[44:47], v[152:155], v[72:75]
    s_waitcnt lgkmcnt(0)
    s_waitcnt vmcnt(8)
    s_barrier
    ds_read_b128 v[40:43], v6 offset:0
    buffer_load_dwordx4 v[36:39], v13, s[20:23], s55 offen
    s_add_u32 s55, s55, 36864
    buffer_load_dwordx4 v[24:27], v13, s[20:23], s55 offen
    s_add_u32 s55, s55, 36864
    v_mfma_f32_16x16x32_bf16 v[76:79], v[44:47], v[156:159], v[76:79]
    buffer_load_dwordx4 v[184:187], v9, s[12:15], s40 offen offset:0
    v_mfma_f32_16x16x32_bf16 v[80:83], v[48:51], v[152:155], v[80:83]
    ds_read_b128 v[44:47], v6 offset:1024
    v_mfma_f32_16x16x32_bf16 v[84:87], v[48:51], v[156:159], v[84:87]
    buffer_load_dwordx4 v[188:191], v9, s[12:15], s40 offen offset:256
    v_mfma_f32_16x16x32_bf16 v[88:91], v[52:55], v[152:155], v[88:91]
    ds_read_b128 v[48:51], v6 offset:2048
    v_mfma_f32_16x16x32_bf16 v[92:95], v[52:55], v[156:159], v[92:95]
    s_cmp_ge_u32 s28, 4
    s_cbranch_scc1 kc_skip_6
    s_add_u32 m0, s31, 73728
    s_add_u32 s38, s67, 73728
    s_sub_u32 s65, s38, 110592
    s_cmp_ge_u32 s38, 110592
    s_cselect_b32 s38, s65, s38
    s_add_u32 s38, s38, s37
    buffer_load_dwordx4 v3, s[8:11], s38 offen lds
kc_skip_6:
    v_mfma_f32_16x16x32_bf16 v[96:99], v[56:59], v[152:155], v[96:99]
    ds_read_b128 v[52:55], v6 offset:3072
    v_mfma_f32_16x16x32_bf16 v[100:103], v[56:59], v[156:159], v[100:103]
    s_add_u32 m0, s36, 73728
    v_mfma_f32_16x16x32_bf16 v[104:107], v[60:63], v[152:155], v[104:107]
    ds_read_b128 v[56:59], v6 offset:4096
    v_mfma_f32_16x16x32_bf16 v[108:111], v[60:63], v[156:159], v[108:111]
    s_add_u32 s38, s66, 73728
    s_sub_u32 s65, s38, 110592
    s_cmp_ge_u32 s38, 110592
    s_cselect_b32 s38, s65, s38
    s_add_u32 s38, s38, s37
    s_waitcnt vmcnt(10)
    s_waitcnt lgkmcnt(3)
    v_mfma_f32_16x16x32_bf16 v[64:67], v[40:43], v[160:163], v[64:67]
    ds_read_b128 v[60:63], v6 offset:5120
    v_mfma_f32_16x16x32_bf16 v[68:71], v[40:43], v[164:167], v[68:71]
    s_mov_b32 s40, s70
    s_add_u32 s70, s70, 0x20000
    s_cmp_ge_u32 s70, 0x240000
    s_cselect_b32 s70, 0, s70
    v_mfma_f32_16x16x32_bf16 v[72:75], v[44:47], v[160:163], v[72:75]
    ds_read_b128 v[40:43], v6 offset:6144
    v_mfma_f32_16x16x32_bf16 v[76:79], v[44:47], v[164:167], v[76:79]
    buffer_load_dwordx4 v[192:195], v9, s[12:15], s40 offen offset:0
    s_waitcnt lgkmcnt(3)
    v_mfma_f32_16x16x32_bf16 v[80:83], v[48:51], v[160:163], v[80:83]
    ds_read_b128 v[44:47], v6 offset:7168
    v_mfma_f32_16x16x32_bf16 v[84:87], v[48:51], v[164:167], v[84:87]
    buffer_load_dwordx4 v[196:199], v9, s[12:15], s40 offen offset:256
    v_mfma_f32_16x16x32_bf16 v[88:91], v[52:55], v[160:163], v[88:91]
    ds_read_b128 v[48:51], v6 offset:8192
    v_mfma_f32_16x16x32_bf16 v[92:95], v[52:55], v[164:167], v[92:95]
    buffer_load_dwordx4 v3, s[8:11], s38 offen offset:0 lds
    s_waitcnt lgkmcnt(3)
    v_mfma_f32_16x16x32_bf16 v[96:99], v[56:59], v[160:163], v[96:99]
    ds_read_b128 v[52:55], v6 offset:9216
    v_mfma_f32_16x16x32_bf16 v[100:103], v[56:59], v[164:167], v[100:103]
    buffer_load_dwordx4 v3, s[8:11], s38 offen offset:1024 lds
    v_mfma_f32_16x16x32_bf16 v[104:107], v[60:63], v[160:163], v[104:107]
    ds_read_b128 v[56:59], v6 offset:10240
    v_mfma_f32_16x16x32_bf16 v[108:111], v[60:63], v[164:167], v[108:111]
    buffer_load_dwordx4 v3, s[8:11], s38 offen offset:2048 lds
    s_waitcnt vmcnt(13)
    s_waitcnt lgkmcnt(3)
    v_mfma_f32_16x16x32_bf16 v[64:67], v[40:43], v[168:171], v[64:67]
    ds_read_b128 v[60:63], v6 offset:11264
    s_waitcnt vmcnt(7)
    v_add_f32 v32, v32, v36
    v_mfma_f32_16x16x32_bf16 v[68:71], v[40:43], v[172:175], v[68:71]
    s_mov_b32 s40, s70
    s_add_u32 s70, s70, 0x20000
    s_cmp_ge_u32 s70, 0x240000
    s_cselect_b32 s70, 0, s70
    v_add_f32 v33, v33, v37
    v_add_f32 v34, v34, v38
    v_mfma_f32_16x16x32_bf16 v[72:75], v[44:47], v[168:171], v[72:75]
    ds_read_b128 v[40:43], v6 offset:12288
    v_add_f32 v35, v35, v39
    v_add_f32 v32, v32, v24
    v_mfma_f32_16x16x32_bf16 v[76:79], v[44:47], v[172:175], v[76:79]
    buffer_load_dwordx4 v[200:203], v9, s[12:15], s40 offen offset:0
    v_add_f32 v33, v33, v25
    v_add_f32 v34, v34, v26
    s_waitcnt lgkmcnt(3)
    v_mfma_f32_16x16x32_bf16 v[80:83], v[48:51], v[168:171], v[80:83]
    ds_read_b128 v[44:47], v6 offset:13312
    v_add_f32 v35, v35, v27
    buffer_load_dwordx4 v[36:39], v13, s[20:23], s55 offen
    s_add_u32 s55, s55, 36864
    v_mfma_f32_16x16x32_bf16 v[84:87], v[48:51], v[172:175], v[84:87]
    buffer_load_dwordx4 v[204:207], v9, s[12:15], s40 offen offset:256
    buffer_load_dwordx4 v[24:27], v13, s[20:23], s55 offen
    s_add_u32 s55, s55, 36864
    buffer_load_dwordx4 v[28:31], v13, s[20:23], s55 offen
    s_add_u32 s55, s55, 36864
    v_mfma_f32_16x16x32_bf16 v[88:91], v[52:55], v[168:171], v[88:91]
    ds_read_b128 v[48:51], v6 offset:14336
    v_mfma_f32_16x16x32_bf16 v[92:95], v[52:55], v[172:175], v[92:95]
    buffer_load_dwordx4 v3, s[8:11], s38 offen offset:3072 lds
    s_waitcnt lgkmcnt(3)
    v_mfma_f32_16x16x32_bf16 v[96:99], v[56:59], v[168:171], v[96:99]
    ds_read_b128 v[52:55], v6 offset:15360
    v_mfma_f32_16x16x32_bf16 v[100:103], v[56:59], v[172:175], v[100:103]
    v_mfma_f32_16x16x32_bf16 v[104:107], v[60:63], v[168:171], v[104:107]
    ds_read_b128 v[56:59], v6 offset:16384
    v_mfma_f32_16x16x32_bf16 v[108:111], v[60:63], v[172:175], v[108:111]
    s_waitcnt lgkmcnt(3)
    v_mfma_f32_16x16x32_bf16 v[64:67], v[40:43], v[176:179], v[64:67]
    ds_read_b128 v[60:63], v6 offset:17408
    v_mfma_f32_16x16x32_bf16 v[68:71], v[40:43], v[180:183], v[68:71]
    s_mov_b32 s40, s70
    s_add_u32 s70, s70, 0x20000
    s_cmp_ge_u32 s70, 0x240000
    s_cselect_b32 s70, 0, s70
    v_mfma_f32_16x16x32_bf16 v[72:75], v[44:47], v[176:179], v[72:75]
    ds_read_b128 v[40:43], v6 offset:18432
    v_mfma_f32_16x16x32_bf16 v[76:79], v[44:47], v[180:183], v[76:79]
    buffer_load_dwordx4 v[208:211], v9, s[12:15], s40 offen offset:0
    s_waitcnt lgkmcnt(3)
    v_mfma_f32_16x16x32_bf16 v[80:83], v[48:51], v[176:179], v[80:83]
    ds_read_b128 v[44:47], v6 offset:19456
    v_mfma_f32_16x16x32_bf16 v[84:87], v[48:51], v[180:183], v[84:87]
    buffer_load_dwordx4 v[212:215], v9, s[12:15], s40 offen offset:256
    v_mfma_f32_16x16x32_bf16 v[88:91], v[52:55], v[176:179], v[88:91]
    ds_read_b128 v[48:51], v6 offset:20480
    v_mfma_f32_16x16x32_bf16 v[92:95], v[52:55], v[180:183], v[92:95]
    s_waitcnt lgkmcnt(3)
    v_mfma_f32_16x16x32_bf16 v[96:99], v[56:59], v[176:179], v[96:99]
    ds_read_b128 v[52:55], v6 offset:21504
    v_mfma_f32_16x16x32_bf16 v[100:103], v[56:59], v[180:183], v[100:103]
    v_mfma_f32_16x16x32_bf16 v[104:107], v[60:63], v[176:179], v[104:107]
    ds_read_b128 v[56:59], v6 offset:22528
    v_mfma_f32_16x16x32_bf16 v[108:111], v[60:63], v[180:183], v[108:111]
    s_waitcnt vmcnt(13)
    s_waitcnt lgkmcnt(3)
    v_mfma_f32_16x16x32_bf16 v[64:67], v[40:43], v[184:187], v[64:67]
    ds_read_b128 v[60:63], v6 offset:23552
    v_mfma_f32_16x16x32_bf16 v[68:71], v[40:43], v[188:191], v[68:71]
    s_mov_b32 s40, s70
    s_add_u32 s70, s70, 0x20000
    s_cmp_ge_u32 s70, 0x240000
    s_cselect_b32 s70, 0, s70
    v_mfma_f32_16x16x32_bf16 v[72:75], v[44:47], v[184:187], v[72:75]
    ds_read_b128 v[40:43], v6 offset:24576
    v_mfma_f32_16x16x32_bf16 v[76:79], v[44:47], v[188:191], v[76:79]
    buffer_load_dwordx4 v[216:219], v9, s[12:15], s40 offen offset:0
    s_waitcnt lgkmcnt(3)
    v_mfma_f32_16x16x32_bf16 v[80:83], v[48:51], v[184:187], v[80:83]
    ds_read_b128 v[44:47], v6 offset:25600
    v_mfma_f32_16x16x32_bf16 v[84:87], v[48:51], v[188:191], v[84:87]
    buffer_load_dwordx4 v[220:223], v9, s[12:15], s40 offen offset:256
    v_mfma_f32_16x16x32_bf16 v[88:91], v[52:55], v[184:187], v[88:91]
    ds_read_b128 v[48:51], v6 offset:26624
    v_mfma_f32_16x16x32_bf16 v[92:95], v[52:55], v[188:191], v[92:95]
    s_waitcnt lgkmcnt(3)
    v_mfma_f32_16x16x32_bf16 v[96:99], v[56:59], v[184:187], v[96:99]
    ds_read_b128 v[52:55], v6 offset:27648
    v_mfma_f32_16x16x32_bf16 v[100:103], v[56:59], v[188:191], v[100:103]
    v_mfma_f32_16x16x32_bf16 v[104:107], v[60:63], v[184:187], v[104:107]
    ds_read_b128 v[56:59], v6 offset:28672
    v_mfma_f32_16x16x32_bf16 v[108:111], v[60:63], v[188:191], v[108:111]
    s_waitcnt vmcnt(13)
    s_waitcnt lgkmcnt(3)
    v_mfma_f32_16x16x32_bf16 v[64:67], v[40:43], v[192:195], v[64:67]
    ds_read_b128 v[60:63], v6 offset:29696
    s_waitcnt vmcnt(5)
    v_add_f32 v32, v32, v36
    v_mfma_f32_16x16x32_bf16 v[68:71], v[40:43], v[196:199], v[68:71]
    s_mov_b32 s40, s70
    s_add_u32 s70, s70, 0x20000
    s_cmp_ge_u32 s70, 0x240000
    s_cselect_b32 s70, 0, s70
    v_add_f32 v33, v33, v37
    v_add_f32 v34, v34, v38
    v_mfma_f32_16x16x32_bf16 v[72:75], v[44:47], v[192:195], v[72:75]
    ds_read_b128 v[40:43], v6 offset:30720
    v_add_f32 v35, v35, v39
    v_add_f32 v32, v32, v24
    v_mfma_f32_16x16x32_bf16 v[76:79], v[44:47], v[196:199], v[76:79]
    buffer_load_dwordx4 v[224:227], v9, s[12:15], s40 offen offset:0
    v_add_f32 v33, v33, v25
    v_add_f32 v34, v34, v26
    s_waitcnt lgkmcnt(3)
    v_mfma_f32_16x16x32_bf16 v[80:83], v[48:51], v[192:195], v[80:83]
    ds_read_b128 v[44:47], v6 offset:31744
    v_add_f32 v35, v35, v27
    v_add_f32 v32, v32, v28
    v_mfma_f32_16x16x32_bf16 v[84:87], v[48:51], v[196:199], v[84:87]
    buffer_load_dwordx4 v[228:231], v9, s[12:15], s40 offen offset:256
    v_add_f32 v33, v33, v29
    v_add_f32 v34, v34, v30
    v_mfma_f32_16x16x32_bf16 v[88:91], v[52:55], v[192:195], v[88:91]
    ds_read_b128 v[48:51], v6 offset:32768
    v_add_f32 v35, v35, v31
    ds_write_b128 v11, v[32:35]
    v_mfma_f32_16x16x32_bf16 v[92:95], v[52:55], v[196:199], v[92:95]
    s_waitcnt lgkmcnt(4)
    v_mfma_f32_16x16x32_bf16 v[96:99], v[56:59], v[192:195], v[96:99]
    ds_read_b128 v[52:55], v6 offset:33792
    v_mfma_f32_16x16x32_bf16 v[100:103], v[56:59], v[196:199], v[100:103]
    v_mfma_f32_16x16x32_bf16 v[104:107], v[60:63], v[192:195], v[104:107]
    ds_read_b128 v[56:59], v6 offset:34816
    v_mfma_f32_16x16x32_bf16 v[108:111], v[60:63], v[196:199], v[108:111]
    s_waitcnt lgkmcnt(4)
    v_mfma_f32_16x16x32_bf16 v[64:67], v[40:43], v[200:203], v[64:67]
    ds_read_b128 v[60:63], v6 offset:35840
    s_mov_b32 s6, 0x510000
    s_mov_b32 s7, 0x00020000
    v_mfma_f32_16x16x32_bf16 v[68:71], v[40:43], v[204:207], v[68:71]
    s_mov_b32 s40, s70
    s_add_u32 s70, s70, 0x20000
    s_cmp_ge_u32 s70, 0x240000
    s_cselect_b32 s70, 0, s70
    s_mov_b32 s62, 0x90a400
    s_mov_b32 s63, 0x00020000
    v_mfma_f32_16x16x32_bf16 v[72:75], v[44:47], v[200:203], v[72:75]
    s_waitcnt lgkmcnt(0)
    s_waitcnt vmcnt(6)
    s_barrier
    ds_read_b128 v[40:43], v7 offset:0
    s_mov_b32 s22, 0x510000
    s_and_b32 s24, s2, 7
    v_mfma_f32_16x16x32_bf16 v[76:79], v[44:47], v[204:207], v[76:79]
    buffer_load_dwordx4 v[232:235], v9, s[12:15], s40 offen offset:0
    s_lshr_b32 s25, s2, 3
    s_lshr_b32 s52, s24, 1
    v_mfma_f32_16x16x32_bf16 v[80:83], v[48:51], v[200:203], v[80:83]
    ds_read_b128 v[44:47], v7 offset:1024
    s_and_b32 s24, s24, 1
    s_lshl_b32 s24, s24, 3
    v_mfma_f32_16x16x32_bf16 v[84:87], v[48:51], v[204:207], v[84:87]
    buffer_load_dwordx4 v[236:239], v9, s[12:15], s40 offen offset:256
    s_lshr_b32 s53, s25, 2
    s_add_u32 s53, s53, s24
    v_mfma_f32_16x16x32_bf16 v[88:91], v[52:55], v[200:203], v[88:91]
    ds_read_b128 v[48:51], v7 offset:2048
    s_and_b32 s54, s25, 3
    s_and_b32 s56, s28, 3
    v_mfma_f32_16x16x32_bf16 v[92:95], v[52:55], v[204:207], v[92:95]
    s_cmp_ge_u32 s28, 4
    s_cbranch_scc1 kc_skip_7
    s_add_u32 m0, s31, 110592
    s_add_u32 s38, s69, 110592
    buffer_load_dwordx4 v3, s[8:11], s38 offen lds
kc_skip_7:
    s_lshr_b32 s57, s28, 2
    s_lshl_b32 s24, s52, 2
    v_mfma_f32_16x16x32_bf16 v[96:99], v[56:59], v[200:203], v[96:99]
    ds_read_b128 v[52:55], v7 offset:3072
    s_add_u32 s24, s24, s54
    s_mul_i32 s39, s24, 331776
    v_mfma_f32_16x16x32_bf16 v[100:103], v[56:59], v[204:207], v[100:103]
    s_add_u32 m0, s36, 110592
    s_lshl_b32 s24, s24, 6
    s_add_u32 s32, s24, 9445376
    v_mfma_f32_16x16x32_bf16 v[104:107], v[60:63], v[200:203], v[104:107]
    ds_read_b128 v[56:59], v7 offset:4096
    s_lshl_b32 s24, s53, 2
    s_add_u32 s33, s32, s24
    v_mfma_f32_16x16x32_bf16 v[108:111], v[60:63], v[204:207], v[108:111]
    s_add_u32 s38, s68, 110592
    s_mul_i32 s41, s52, 4718592
    s_mul_i32 s24, s57, 1179648
    s_waitcnt vmcnt(6)
    s_waitcnt lgkmcnt(3)
    v_mfma_f32_16x16x32_bf16 v[64:67], v[40:43], v[208:211], v[64:67]
    ds_read_b128 v[60:63], v7 offset:5120
    s_add_u32 s41, s41, s24
    s_lshl_b32 s24, s30, 3
    v_mfma_f32_16x16x32_bf16 v[68:71], v[40:43], v[212:215], v[68:71]
    s_mov_b32 s40, s70
    s_add_u32 s70, s70, 0x20000
    s_cmp_ge_u32 s70, 0x240000
    s_cselect_b32 s70, 0, s70
    s_add_u32 s24, s24, s28
    s_lshl_b32 s24, s24, 5
    v_mfma_f32_16x16x32_bf16 v[72:75], v[44:47], v[208:211], v[72:75]
    ds_read_b128 v[40:43], v7 offset:6144
    s_add_u32 s24, s24, s29
    s_lshl_b32 s24, s24, 2
    v_mfma_f32_16x16x32_bf16 v[76:79], v[44:47], v[212:215], v[76:79]
    buffer_load_dwordx4 v[240:243], v9, s[12:15], s40 offen offset:0
    s_add_u32 s55, s24, 9437184
    s_lshl_b32 s24, s53, 7
    s_waitcnt lgkmcnt(3)
    v_mfma_f32_16x16x32_bf16 v[80:83], v[48:51], v[208:211], v[80:83]
    ds_read_b128 v[44:47], v7 offset:7168
    s_lshl_b32 s25, s52, 3
    s_add_u32 s24, s24, s25
    v_mfma_f32_16x16x32_bf16 v[84:87], v[48:51], v[212:215], v[84:87]
    buffer_load_dwordx4 v[244:247], v9, s[12:15], s40 offen offset:256
    s_lshl_b32 s24, s24, 2
    s_add_u32 s71, s24, 9437184
    v_mfma_f32_16x16x32_bf16 v[88:91], v[52:55], v[208:211], v[88:91]
    ds_read_b128 v[48:51], v7 offset:8192
    s_lshl_b32 s24, s53, 3
    s_add_u32 s24, s24, s28
    v_mfma_f32_16x16x32_bf16 v[92:95], v[52:55], v[212:215], v[92:95]
    buffer_load_dwordx4 v3, s[8:11], s38 offen offset:0 lds
    s_mul_i32 s35, s24, 3072
    s_add_u32 s35, s35, s39
    s_waitcnt lgkmcnt(3)
    v_mfma_f32_16x16x32_bf16 v[96:99], v[56:59], v[208:211], v[96:99]
    ds_read_b128 v[52:55], v7 offset:9216
    s_mul_i32 s25, s24, 171
    s_lshr_b32 s25, s25, 9
    v_mfma_f32_16x16x32_bf16 v[100:103], v[56:59], v[212:215], v[100:103]
    buffer_load_dwordx4 v3, s[8:11], s38 offen offset:1024 lds
    s_mul_i32 s34, s25, 3
    s_sub_u32 s34, s24, s34
    v_mfma_f32_16x16x32_bf16 v[104:107], v[60:63], v[208:211], v[104:107]
    ds_read_b128 v[56:59], v7 offset:10240
    s_mul_i32 s34, s34, 96
    s_mul_i32 s64, s54, 288
    v_mfma_f32_16x16x32_bf16 v[108:111], v[60:63], v[212:215], v[108:111]
    buffer_load_dwordx4 v3, s[8:11], s38 offen offset:2048 lds
    s_add_u32 s34, s34, s64
    s_lshr_b32 s64, s25, 2
    s_waitcnt vmcnt(9)
    s_waitcnt lgkmcnt(3)
    v_mfma_f32_16x16x32_bf16 v[64:67], v[40:43], v[216:219], v[64:67]
    ds_read_b128 v[60:63], v7 offset:11264
    s_and_b32 s25, s25, 3
    s_mul_i32 s25, s25, 288
    v_mfma_f32_16x16x32_bf16 v[68:71], v[40:43], v[220:223], v[68:71]
    s_mov_b32 s40, s70
    s_add_u32 s70, s70, 0x20000
    s_cmp_ge_u32 s70, 0x240000
    s_cselect_b32 s70, 0, s70
    s_lshl_b32 s64, s64, 4
    s_add_u32 s25, s25, s64
    v_mfma_f32_16x16x32_bf16 v[72:75], v[44:47], v[216:219], v[72:75]
    ds_read_b128 v[40:43], v7 offset:12288
    s_mul_i32 s64, s52, 1152
    s_add_u32 s25, s25, s64
    v_mfma_f32_16x16x32_bf16 v[76:79], v[44:47], v[220:223], v[76:79]
    buffer_load_dwordx4 v[248:251], v9, s[12:15], s40 offen offset:0
    s_mul_i32 s25, s25, 1152
    s_add_u32 s34, s34, s25
    s_waitcnt lgkmcnt(3)
    v_mfma_f32_16x16x32_bf16 v[80:83], v[48:51], v[216:219], v[80:83]
    ds_read_b128 v[44:47], v7 offset:13312
    s_cmp_ge_u32 s24, 108
    s_cselect_b32 s34, 0x510000, s34
    s_cselect_b32 s35, 0x510000, s35
    s_add_u32 s60, s26, 0x1d40000
    s_addc_u32 s61, s27, 0
    v_mfma_f32_16x16x32_bf16 v[84:87], v[48:51], v[220:223], v[84:87]
    buffer_load_dwordx4 v[252:255], v9, s[12:15], s40 offen offset:256
    s_add_u32 s20, s26, 0x399e000
    s_addc_u32 s21, s27, 0
    v_lshrrev_b32 v4, 5, v2
    v_mfma_f32_16x16x32_bf16 v[88:91], v[52:55], v[216:219], v[88:91]
    ds_read_b128 v[48:51], v7 offset:14336
    v_mul_u32_u24 v4, 144, v4
    v_bfe_u32 v5, v2, 1, 4
    v_mfma_f32_16x16x32_bf16 v[92:95], v[52:55], v[220:223], v[92:95]
    buffer_load_dwordx4 v3, s[8:11], s38 offen offset:3072 lds
    v_add_u32 v4, v4, v5
    v_mul_u32_u24 v4, 1152, v4
    s_waitcnt lgkmcnt(3)
    v_mfma_f32_16x16x32_bf16 v[96:99], v[56:59], v[216:219], v[96:99]
    ds_read_b128 v[52:55], v7 offset:15360
    v_and_b32 v5, 1, v2
    v_mul_u32_u24 v5, 92, v5
    v_mfma_f32_16x16x32_bf16 v[100:103], v[56:59], v[220:223], v[100:103]
    v_add_u32 v24, v5, v4
    buffer_load_dword v25, v24, s[4:7], s34 offen
    v_mfma_f32_16x16x32_bf16 v[104:107], v[60:63], v[216:219], v[104:107]
    ds_read_b128 v[56:59], v7 offset:16384
    v_mfma_f32_16x16x32_bf16 v[108:111], v[60:63], v[220:223], v[108:111]
    s_waitcnt vmcnt(11)
    s_waitcnt lgkmcnt(3)
    v_mfma_f32_16x16x32_bf16 v[64:67], v[40:43], v[224:227], v[64:67]
    ds_read_b128 v[60:63], v7 offset:17408
    buffer_load_dwordx2 v[16:17], v12, s[48:51], 0 offen offset:0 sc1
    buffer_load_dwordx2 v[20:21], v12, s[48:51], 0 offen offset:128 sc1
    v_mfma_f32_16x16x32_bf16 v[68:71], v[40:43], v[228:231], v[68:71]
    v_mfma_f32_16x16x32_bf16 v[72:75], v[44:47], v[224:227], v[72:75]
    ds_read_b128 v[40:43], v7 offset:18432
    v_mfma_f32_16x16x32_bf16 v[76:79], v[44:47], v[228:231], v[76:79]
    s_waitcnt lgkmcnt(3)
    v_mfma_f32_16x16x32_bf16 v[80:83], v[48:51], v[224:227], v[80:83]
    ds_read_b128 v[44:47], v7 offset:19456
    v_mfma_f32_16x16x32_bf16 v[84:87], v[48:51], v[228:231], v[84:87]
    v_mfma_f32_16x16x32_bf16 v[88:91], v[52:55], v[224:227], v[88:91]
    ds_read_b128 v[48:51], v7 offset:20480
    v_mfma_f32_16x16x32_bf16 v[92:95], v[52:55], v[228:231], v[92:95]
    s_waitcnt lgkmcnt(3)
    v_mfma_f32_16x16x32_bf16 v[96:99], v[56:59], v[224:227], v[96:99]
    ds_read_b128 v[52:55], v7 offset:21504
    v_mfma_f32_16x16x32_bf16 v[100:103], v[56:59], v[228:231], v[100:103]
    v_mfma_f32_16x16x32_bf16 v[104:107], v[60:63], v[224:227], v[104:107]
    ds_read_b128 v[56:59], v7 offset:22528
    v_mfma_f32_16x16x32_bf16 v[108:111], v[60:63], v[228:231], v[108:111]
    s_waitcnt vmcnt(11)
    s_waitcnt lgkmcnt(3)
    v_mfma_f32_16x16x32_bf16 v[64:67], v[40:43], v[232:235], v[64:67]
    ds_read_b128 v[60:63], v7 offset:23552
    v_mfma_f32_16x16x32_bf16 v[68:71], v[40:43], v[236:239], v[68:71]
    v_mfma_f32_16x16x32_bf16 v[72:75], v[44:47], v[232:235], v[72:75]
    ds_read_b128 v[40:43], v7 offset:24576
    v_mfma_f32_16x16x32_bf16 v[76:79], v[44:47], v[236:239], v[76:79]
    s_waitcnt lgkmcnt(3)
    v_mfma_f32_16x16x32_bf16 v[80:83], v[48:51], v[232:235], v[80:83]
    ds_read_b128 v[44:47], v7 offset:25600
    v_mfma_f32_16x16x32_bf16 v[84:87], v[48:51], v[236:239], v[84:87]
    v_mfma_f32_16x16x32_bf16 v[88:91], v[52:55], v[232:235], v[88:91]
    ds_read_b128 v[48:51], v7 offset:26624
    v_mfma_f32_16x16x32_bf16 v[92:95], v[52:55], v[236:239], v[92:95]
    s_waitcnt lgkmcnt(3)
    v_mfma_f32_16x16x32_bf16 v[96:99], v[56:59], v[232:235], v[96:99]
    ds_read_b128 v[52:55], v7 offset:27648
    v_mfma_f32_16x16x32_bf16 v[100:103], v[56:59], v[236:239], v[100:103]
    v_mfma_f32_16x16x32_bf16 v[104:107], v[60:63], v[232:235], v[104:107]
    ds_read_b128 v[56:59], v7 offset:28672
    v_mfma_f32_16x16x32_bf16 v[108:111], v[60:63], v[236:239], v[108:111]
    s_waitcnt vmcnt(9)
    s_waitcnt lgkmcnt(3)
    v_mfma_f32_16x16x32_bf16 v[64:67], v[40:43], v[240:243], v[64:67]
    ds_read_b128 v[60:63], v7 offset:29696
    v_mfma_f32_16x16x32_bf16 v[68:71], v[40:43], v[244:247], v[68:71]
    v_mfma_f32_16x16x32_bf16 v[72:75], v[44:47], v[240:243], v[72:75]
    ds_read_b128 v[40:43], v7 offset:30720
    v_mfma_f32_16x16x32_bf16 v[76:79], v[44:47], v[244:247], v[76:79]
    s_waitcnt lgkmcnt(3)
    v_mfma_f32_16x16x32_bf16 v[80:83], v[48:51], v[240:243], v[80:83]
    ds_read_b128 v[44:47], v7 offset:31744
    v_mfma_f32_16x16x32_bf16 v[84:87], v[48:51], v[244:247], v[84:87]
    v_mfma_f32_16x16x32_bf16 v[88:91], v[52:55], v[240:243], v[88:91]
    ds_read_b128 v[48:51], v7 offset:32768
    v_mfma_f32_16x16x32_bf16 v[92:95], v[52:55], v[244:247], v[92:95]
    s_waitcnt lgkmcnt(3)
    v_mfma_f32_16x16x32_bf16 v[96:99], v[56:59], v[240:243], v[96:99]
    ds_read_b128 v[52:55], v7 offset:33792
    v_mfma_f32_16x16x32_bf16 v[100:103], v[56:59], v[244:247], v[100:103]
    v_mfma_f32_16x16x32_bf16 v[104:107], v[60:63], v[240:243], v[104:107]
    ds_read_b128 v[56:59], v7 offset:34816
    v_mfma_f32_16x16x32_bf16 v[108:111], v[60:63], v[244:247], v[108:111]
    s_waitcnt vmcnt(4)
    s_waitcnt lgkmcnt(3)
    v_mfma_f32_16x16x32_bf16 v[64:67], v[40:43], v[248:251], v[64:67]
    ds_read_b128 v[60:63], v7 offset:35840
    ds_read_b128 v[32:35], v10 offset:0
    ds_read_b128 v[36:39], v10 offset:1024
    s_waitcnt vmcnt(0)
    v_cmp_eq_u32 vcc, -1, v17
    v_cmp_eq_u32 s[58:59], -1, v21
    s_nop 1
    s_or_b64 vcc, vcc, s[58:59]
    s_cbranch_vccnz kc_slowstat
kc_statok:
    v_mfma_f32_16x16x32_bf16 v[68:71], v[40:43], v[252:255], v[68:71]
    s_mov_b32 s45, 0xc0135761
    s_mov_b32 s46, 0xbdd2d3e8
    v_mfma_f32_16x16x32_bf16 v[72:75], v[44:47], v[248:251], v[72:75]
    s_waitcnt lgkmcnt(0)
    s_barrier
    ds_read_b128 v[40:43], v8 offset:0
    v_rsq_f32 v18, v17
    v_sub_f32 v16, 0, v16
    v_mfma_f32_16x16x32_bf16 v[76:79], v[44:47], v[252:255], v[76:79]
    s_cmp_ge_u32 s28, 4
    s_cbranch_scc1 kc_skip_8
    s_add_u32 m0, s31, 0
    s_add_u32 s38, s69, 147456
    buffer_load_dwordx4 v3, s[8:11], s38 offen lds
kc_skip_8:
    v_mul_f32 v19, v18, v18
    v_mul_f32 v19, v19, v18
    v_mfma_f32_16x16x32_bf16 v[80:83], v[48:51], v[248:251], v[80:83]
    ds_read_b128 v[44:47], v8 offset:1024
    v_mul_f32 v19, s46, v19
    v_mul_f32 v18, s45, v18
    v_mfma_f32_16x16x32_bf16 v[84:87], v[48:51], v[252:255], v[84:87]
    s_add_u32 m0, s36, 0
    v_rsq_f32 v22, v21
    v_sub_f32 v20, 0, v20
    v_mfma_f32_16x16x32_bf16 v[88:91], v[52:55], v[248:251], v[88:91]
    ds_read_b128 v[48:51], v8 offset:2048
    v_mul_f32 v23, v22, v22
    v_mul_f32 v23, v23, v22
    v_mfma_f32_16x16x32_bf16 v[92:95], v[52:55], v[252:255], v[92:95]
    s_add_u32 s38, s68, 147456
    v_mul_f32 v23, s46, v23
    v_mul_f32 v22, s45, v22
    v_mfma_f32_16x16x32_bf16 v[96:99], v[56:59], v[248:251], v[96:99]
    ds_read_b128 v[52:55], v8 offset:3072
    v_mfma_f32_16x16x32_bf16 v[100:103], v[56:59], v[252:255], v[100:103]
    buffer_load_dwordx4 v3, s[8:11], s38 offen offset:0 lds
    v_mfma_f32_16x16x32_bf16 v[104:107], v[60:63], v[248:251], v[104:107]
    ds_read_b128 v[56:59], v8 offset:4096
    v_mfma_f32_16x16x32_bf16 v[108:111], v[60:63], v[252:255], v[108:111]
    buffer_load_dwordx4 v3, s[8:11], s38 offen offset:1024 lds
    s_nop 3
    v_fmac_f32 v64, v32, v16
    v_fmac_f32 v72, v36, v16
    v_fmac_f32 v65, v33, v16
    v_fmac_f32 v73, v37, v16
    v_mul_f32 v24, v64, v64
    v_fmac_f32 v66, v34, v16
    v_fmac_f32 v74, v38, v16
    v_mul_f32 v25, v65, v65
    v_fma_f32 v24, v24, v19, v18
    v_fmac_f32 v67, v35, v16
    v_fmac_f32 v75, v39, v16
    v_mul_f32 v26, v66, v66
    v_fma_f32 v25, v25, v19, v18
    v_mul_f32 v24, v24, v64
    v_fmac_f32 v68, v32, v20
    v_fmac_f32 v76, v36, v20
    v_mul_f32 v27, v67, v67
    v_exp_f32 v24, v24
    v_mul_f32 v64, v64, v72
    v_fma_f32 v26, v26, v19, v18
    v_mul_f32 v25, v25, v65
    v_fmac_f32 v69, v33, v20
    v_fmac_f32 v77, v37, v20
    v_mul_f32 v28, v68, v68
    v_exp_f32 v25, v25
    v_mul_f32 v65, v65, v73
    v_fma_f32 v27, v27, v19, v18
    v_mul_f32 v26, v26, v66
    v_fma_f32 v24, v24, v17, v17
    v_rcp_f32 v24, v24
    v_fmac_f32 v70, v34, v20
    v_fmac_f32 v78, v38, v20
    v_mul_f32 v29, v69, v69
    v_exp_f32 v26, v26
    v_mul_f32 v66, v66, v74
    v_fma_f32 v28, v28, v23, v22
    v_mul_f32 v27, v27, v67
    v_fma_f32 v25, v25, v17, v17
    v_rcp_f32 v25, v25
    v_fmac_f32 v71, v35, v20
    v_fmac_f32 v79, v39, v20
    v_mul_f32 v30, v70, v70
    v_mul_f32 v64, v64, v24
    v_exp_f32 v27, v27
    v_mul_f32 v67, v67, v75
    v_fma_f32 v29, v29, v23, v22
    v_mul_f32 v28, v28, v68
    v_fma_f32 v26, v26, v17, v17
    ds_read_b128 v[32:35], v10 offset:64
    ds_read_b128 v[36:39], v10 offset:1088
    v_rcp_f32 v26, v26
    v_mul_f32 v31, v71, v71
    v_mul_f32 v65, v65, v25
    v_exp_f32 v28, v28
    v_mul_f32 v68, v68, v76
    v_fma_f32 v30, v30, v23, v22
    v_mul_f32 v29, v29, v69
    v_fma_f32 v27, v27, v17, v17
    v_rcp_f32 v27, v27
    v_mul_f32 v66, v66, v26
    v_exp_f32 v29, v29
    v_mul_f32 v69, v69, v77
    v_fma_f32 v31, v31, v23, v22
    v_mul_f32 v30, v30, v70
    v_fma_f32 v28, v28, v21, v21
    v_rcp_f32 v28, v28
    v_mul_f32 v67, v67, v27
    v_exp_f32 v30, v30
    v_mul_f32 v70, v70, v78
    v_mul_f32 v31, v31, v71
    v_fma_f32 v29, v29, v21, v21
    v_rcp_f32 v29, v29
    v_mul_f32 v68, v68, v28
    v_exp_f32 v31, v31
    v_mul_f32 v71, v71, v79
    v_fma_f32 v30, v30, v21, v21
    v_rcp_f32 v30, v30
    v_mul_f32 v69, v69, v29
    v_fma_f32 v31, v31, v21, v21
    v_rcp_f32 v31, v31
    v_mul_f32 v70, v70, v30
    s_nop 0
    v_mul_f32 v71, v71, v31
    v_cvt_pk_bf16_f32 v24, v64, v65
    v_cvt_pk_bf16_f32 v25, v66, v67
    v_cvt_pk_bf16_f32 v26, v68, v69
    v_cvt_pk_bf16_f32 v27, v70, v71
    s_add_u32 s43, s42, 0
    s_nop 0
    v_permlane16_swap_b32 v24, v26
    v_permlane16_swap_b32 v25, v27
    buffer_store_dwordx4 v[24:27], v1, s[16:19], s43 offen sc1
    s_nop 0
    s_waitcnt lgkmcnt(5)
    v_mfma_f32_16x16x32_bf16 v[64:67], v[40:43], v[112:115], 0
    ds_read_b128 v[60:63], v8 offset:5120
    s_waitcnt lgkmcnt(1)
    v_fmac_f32 v80, v32, v16
    v_mfma_f32_16x16x32_bf16 v[68:71], v[40:43], v[116:119], 0
    buffer_load_dwordx4 v3, s[8:11], s38 offen offset:2048 lds
    v_fmac_f32 v88, v36, v16
    v_fmac_f32 v81, v33, v16
    v_mfma_f32_16x16x32_bf16 v[72:75], v[44:47], v[112:115], 0
    ds_read_b128 v[40:43], v8 offset:6144
    v_fmac_f32 v89, v37, v16
    v_mul_f32 v24, v80, v80
    v_mfma_f32_16x16x32_bf16 v[76:79], v[44:47], v[116:119], 0
    buffer_load_dwordx4 v3, s[8:11], s38 offen offset:3072 lds
    v_fmac_f32 v82, v34, v16
    v_fmac_f32 v90, v38, v16
    v_mfma_f32_16x16x32_bf16 v[64:67], v[48:51], v[120:123], v[64:67]
    ds_read_b128 v[44:47], v8 offset:7168
    v_lshrrev_b32 v4, 5, v2
    v_mul_u32_u24 v4, 144, v4
    v_mfma_f32_16x16x32_bf16 v[68:71], v[48:51], v[124:127], v[68:71]
    s_cmp_ge_u32 s28, 4
    s_cbranch_scc1 kc_skip_9
    s_add_u32 m0, s31, 36864
    s_add_u32 s38, s69, 184320
    buffer_load_dwordx4 v3, s[8:11], s38 offen lds
kc_skip_9:
    v_bfe_u32 v5, v2, 1, 4
    v_add_u32 v4, v4, v5
    v_mfma_f32_16x16x32_bf16 v[72:75], v[52:55], v[120:123], v[72:75]
    ds_read_b128 v[48:51], v8 offset:8192
    v_mul_u32_u24 v4, 1152, v4
    v_and_b32 v5, 1, v2
    v_mfma_f32_16x16x32_bf16 v[76:79], v[52:55], v[124:127], v[76:79]
    s_add_u32 m0, s36, 36864
    v_lshl_add_u32 v9, v5, 4, v4
    v_lshrrev_b32 v4, 4, v2
    s_waitcnt lgkmcnt(3)
    v_mfma_f32_16x16x32_bf16 v[64:67], v[56:59], v[128:131], v[64:67]
    ds_read_b128 v[52:55], v8 offset:9216
    v_lshlrev_b32 v4, 3, v4
    v_bfe_u32 v5, v2, 2, 2
    v_mfma_f32_16x16x32_bf16 v[68:71], v[56:59], v[132:135], v[68:71]
    s_add_u32 s38, s68, 184320
    v_add_u32 v4, v4, v5
    v_lshlrev_b32 v4, 5, v4
    v_mfma_f32_16x16x32_bf16 v[72:75], v[60:63], v[128:131], v[72:75]
    ds_read_b128 v[56:59], v8 offset:10240
    v_and_b32 v5, 3, v2
    v_lshl_add_u32 v4, v5, 3, v4
    v_mfma_f32_16x16x32_bf16 v[76:79], v[60:63], v[132:135], v[76:79]
    buffer_load_dwordx4 v3, s[8:11], s38 offen offset:0 lds
    s_lshl_b32 s64, s28, 10
    s_add_u32 s64, s64, 149504
    s_waitcnt lgkmcnt(3)
    v_mfma_f32_16x16x32_bf16 v[64:67], v[40:43], v[136:139], v[64:67]
    ds_read_b128 v[60:63], v8 offset:11264
    v_add_u32 v11, s64, v4
    v_mfma_f32_16x16x32_bf16 v[68:71], v[40:43], v[140:143], v[68:71]
    buffer_load_dwordx4 v3, s[8:11], s38 offen offset:1024 lds
    v_mul_f32 v25, v81, v81
    v_fma_f32 v24, v24, v19, v18
    v_mfma_f32_16x16x32_bf16 v[72:75], v[44:47], v[136:139], v[72:75]
    ds_read_b128 v[40:43], v8 offset:12288
    v_fmac_f32 v83, v35, v16
    v_fmac_f32 v91, v39, v16
    v_mfma_f32_16x16x32_bf16 v[76:79], v[44:47], v[140:143], v[76:79]
    buffer_load_dwordx4 v3, s[8:11], s38 offen offset:2048 lds
    v_mul_f32 v26, v82, v82
    v_fma_f32 v25, v25, v19, v18
    s_waitcnt lgkmcnt(3)
    v_mfma_f32_16x16x32_bf16 v[64:67], v[48:51], v[144:147], v[64:67]
    ds_read_b128 v[44:47], v8 offset:13312
    v_mul_f32 v24, v24, v80
    v_fmac_f32 v84, v32, v20
    v_mfma_f32_16x16x32_bf16 v[68:71], v[48:51], v[148:151], v[68:71]
    buffer_load_dwordx4 v3, s[8:11], s38 offen offset:3072 lds
    v_fmac_f32 v92, v36, v20
    v_mul_f32 v27, v83, v83
    v_mfma_f32_16x16x32_bf16 v[72:75], v[52:55], v[144:147], v[72:75]
    ds_read_b128 v[48:51], v8 offset:14336
    v_exp_f32 v24, v24
    v_mul_f32 v80, v80, v88
    v_mfma_f32_16x16x32_bf16 v[76:79], v[52:55], v[148:151], v[76:79]
    s_mov_b32 m0, s64
    s_nop 0
    buffer_load_dwordx4 v9, s[4:7], s34 offen lds
    s_add_u32 s34, s34, 32
    v_fma_f32 v26, v26, v19, v18
    v_mul_f32 v25, v25, v81
    s_waitcnt lgkmcnt(3)
    v_mfma_f32_16x16x32_bf16 v[64:67], v[56:59], v[152:155], v[64:67]
    ds_read_b128 v[52:55], v8 offset:15360
    v_fmac_f32 v85, v33, v20
    v_fmac_f32 v93, v37, v20
    v_mfma_f32_16x16x32_bf16 v[68:71], v[56:59], v[156:159], v[68:71]
    v_mul_f32 v28, v84, v84
    v_exp_f32 v25, v25
    v_mfma_f32_16x16x32_bf16 v[72:75], v[60:63], v[152:155], v[72:75]
    ds_read_b128 v[56:59], v8 offset:16384
    v_mul_f32 v81, v81, v89
    v_fma_f32 v27, v27, v19, v18
    v_mfma_f32_16x16x32_bf16 v[76:79], v[60:63], v[156:159], v[76:79]
    v_mul_f32 v26, v26, v82
    v_fma_f32 v24, v24, v17, v17
    s_waitcnt lgkmcnt(3)
    v_mfma_f32_16x16x32_bf16 v[64:67], v[40:43], v[160:163], v[64:67]
    ds_read_b128 v[60:63], v8 offset:17408
    v_rcp_f32 v24, v24
    v_fmac_f32 v86, v34, v20
    v_mfma_f32_16x16x32_bf16 v[68:71], v[40:43], v[164:167], v[68:71]
    v_fmac_f32 v94, v38, v20
    v_mul_f32 v29, v85, v85
    v_mfma_f32_16x16x32_bf16 v[72:75], v[44:47], v[160:163], v[72:75]
    ds_read_b128 v[40:43], v8 offset:18432
    v_exp_f32 v26, v26
    v_mul_f32 v82, v82, v90
    v_mfma_f32_16x16x32_bf16 v[76:79], v[44:47], v[164:167], v[76:79]
    v_fma_f32 v28, v28, v23, v22
    v_mul_f32 v27, v27, v83
    s_waitcnt lgkmcnt(3)
    v_mfma_f32_16x16x32_bf16 v[64:67], v[48:51], v[168:171], v[64:67]
    ds_read_b128 v[44:47], v8 offset:19456
    v_fma_f32 v25, v25, v17, v17
    v_rcp_f32 v25, v25
    v_mfma_f32_16x16x32_bf16 v[68:71], v[48:51], v[172:175], v[68:71]
    v_fmac_f32 v87, v35, v20
    v_fmac_f32 v95, v39, v20
    v_mfma_f32_16x16x32_bf16 v[72:75], v[52:55], v[168:171], v[72:75]
    ds_read_b128 v[48:51], v8 offset:20480
    v_mul_f32 v30, v86, v86
    v_mul_f32 v80, v80, v24
    v_mfma_f32_16x16x32_bf16 v[76:79], v[52:55], v[172:175], v[76:79]
    v_exp_f32 v27, v27
    v_mul_f32 v83, v83, v91
    s_waitcnt lgkmcnt(3)
    v_mfma_f32_16x16x32_bf16 v[64:67], v[56:59], v[176:179], v[64:67]
    ds_read_b128 v[52:55], v8 offset:21504
    v_fma_f32 v29, v29, v23, v22
    v_mul_f32 v28, v28, v84
    v_mfma_f32_16x16x32_bf16 v[68:71], v[56:59], v[180:183], v[68:71]
    v_fma_f32 v26, v26, v17, v17
    ds_read_b128 v[32:35], v10 offset:128
    ds_read_b128 v[36:39], v10 offset:1152
    v_mfma_f32_16x16x32_bf16 v[72:75], v[60:63], v[176:179], v[72:75]
    ds_read_b128 v[56:59], v8 offset:22528
    v_rcp_f32 v26, v26
    v_mul_f32 v31, v87, v87
    v_mfma_f32_16x16x32_bf16 v[76:79], v[60:63], v[180:183], v[76:79]
    v_mul_f32 v81, v81, v25
    v_exp_f32 v28, v28
    s_waitcnt lgkmcnt(5)
    v_mfma_f32_16x16x32_bf16 v[64:67], v[40:43], v[184:187], v[64:67]
    ds_read_b128 v[60:63], v8 offset:23552
    v_mul_f32 v84, v84, v92
    v_fma_f32 v30, v30, v23, v22
    v_mfma_f32_16x16x32_bf16 v[68:71], v[40:43], v[188:191], v[68:71]
    v_mul_f32 v29, v29, v85
    v_fma_f32 v27, v27, v17, v17
    v_mfma_f32_16x16x32_bf16 v[72:75], v[44:47], v[184:187], v[72:75]
    ds_read_b128 v[40:43], v8 offset:24576
    v_rcp_f32 v27, v27
    v_mul_f32 v82, v82, v26
    v_mfma_f32_16x16x32_bf16 v[76:79], v[44:47], v[188:191], v[76:79]
    v_exp_f32 v29, v29
    v_mul_f32 v85, v85, v93
    s_waitcnt lgkmcnt(5)
    v_mfma_f32_16x16x32_bf16 v[64:67], v[48:51], v[192:195], v[64:67]
    ds_read_b128 v[44:47], v8 offset:25600
    v_fma_f32 v31, v31, v23, v22
    v_mul_f32 v30, v30, v86
    v_mfma_f32_16x16x32_bf16 v[68:71], v[48:51], v[196:199], v[68:71]
    v_fma_f32 v28, v28, v21, v21
    v_rcp_f32 v28, v28
    v_mfma_f32_16x16x32_bf16 v[72:75], v[52:55], v[192:195], v[72:75]
    ds_read_b128 v[48:51], v8 offset:26624
    v_mul_f32 v83, v83, v27
    v_exp_f32 v30, v30
    v_mfma_f32_16x16x32_bf16 v[76:79], v[52:55], v[196:199], v[76:79]
    v_mul_f32 v86, v86, v94
    v_mul_f32 v31, v31, v87
    s_waitcnt lgkmcnt(3)
    v_mfma_f32_16x16x32_bf16 v[64:67], v[56:59], v[200:203], v[64:67]
    ds_read_b128 v[52:55], v8 offset:27648
    v_fma_f32 v29, v29, v21, v21
    v_rcp_f32 v29, v29
    v_mfma_f32_16x16x32_bf16 v[68:71], v[56:59], v[204:207], v[68:71]
    v_mul_f32 v84, v84, v28
    v_exp_f32 v31, v31
    v_mfma_f32_16x16x32_bf16 v[72:75], v[60:63], v[200:203], v[72:75]
    ds_read_b128 v[56:59], v8 offset:28672
    v_mul_f32 v87, v87, v95
    v_fma_f32 v30, v30, v21, v21
    v_mfma_f32_16x16x32_bf16 v[76:79], v[60:63], v[204:207], v[76:79]
    v_rcp_f32 v30, v30
    v_mul_f32 v85, v85, v29
    s_waitcnt lgkmcnt(3)
    v_mfma_f32_16x16x32_bf16 v[64:67], v[40:43], v[208:211], v[64:67]
    ds_read_b128 v[60:63], v8 offset:29696
    v_fma_f32 v31, v31, v21, v21
    v_rcp_f32 v31, v31
    v_mfma_f32_16x16x32_bf16 v[68:71], v[40:43], v[212:215], v[68:71]
    v_mul_f32 v86, v86, v30
    s_nop 0
    v_mfma_f32_16x16x32_bf16 v[72:75], v[44:47], v[208:211], v[72:75]
    ds_read_b128 v[40:43], v8 offset:30720
    v_mul_f32 v87, v87, v31
    v_cvt_pk_bf16_f32 v24, v80, v81
    v_mfma_f32_16x16x32_bf16 v[76:79], v[44:47], v[212:215], v[76:79]
    v_cvt_pk_bf16_f32 v25, v82, v83
    v_cvt_pk_bf16_f32 v26, v84, v85
    s_waitcnt lgkmcnt(3)
    v_mfma_f32_16x16x32_bf16 v[64:67], v[48:51], v[216:219], v[64:67]
    ds_read_b128 v[44:47], v8 offset:31744
    v_cvt_pk_bf16_f32 v27, v86, v87
    s_add_u32 s43, s42, 65536
    v_mfma_f32_16x16x32_bf16 v[68:71], v[48:51], v[220:223], v[68:71]
    s_nop 0
    v_permlane16_swap_b32 v24, v26
    v_mfma_f32_16x16x32_bf16 v[72:75], v[52:55], v[216:219], v[72:75]
    ds_read_b128 v[48:51], v8 offset:32768
    v_permlane16_swap_b32 v25, v27
    buffer_store_dwordx4 v[24:27], v1, s[16:19], s43 offen sc1
    v_mfma_f32_16x16x32_bf16 v[76:79], v[52:55], v[220:223], v[76:79]
    s_nop 0
    s_waitcnt lgkmcnt(3)
    v_mfma_f32_16x16x32_bf16 v[64:67], v[56:59], v[224:227], v[64:67]
    ds_read_b128 v[52:55], v8 offset:33792
    v_fmac_f32 v96, v32, v16
    v_fmac_f32 v104, v36, v16
    v_mfma_f32_16x16x32_bf16 v[68:71], v[56:59], v[228:231], v[68:71]
    v_fmac_f32 v97, v33, v16
    v_fmac_f32 v105, v37, v16
    v_mfma_f32_16x16x32_bf16 v[72:75], v[60:63], v[224:227], v[72:75]
    ds_read_b128 v[56:59], v8 offset:34816
    v_mul_f32 v24, v96, v96
    v_fmac_f32 v98, v34, v16
    v_mfma_f32_16x16x32_bf16 v[76:79], v[60:63], v[228:231], v[76:79]
    v_fmac_f32 v106, v38, v16
    v_mul_f32 v25, v97, v97
    s_waitcnt lgkmcnt(3)
    v_mfma_f32_16x16x32_bf16 v[64:67], v[40:43], v[232:235], v[64:67]
    ds_read_b128 v[60:63], v8 offset:35840
    s_waitcnt vmcnt(1)
    ds_read_b64_tr_b16 v[12:13], v11
    ds_read_b64_tr_b16 v[14:15], v11 offset:128
    v_fma_f32 v24, v24, v19, v18
    v_mfma_f32_16x16x32_bf16 v[68:71], v[40:43], v[236:239], v[68:71]
    v_fmac_f32 v99, v35, v16
    v_fmac_f32 v107, v39, v16
    v_mfma_f32_16x16x32_bf16 v[72:75], v[44:47], v[232:235], v[72:75]
    s_waitcnt lgkmcnt(0)
    s_barrier
    ds_read_b128 v[40:43], v3 offset:0
    v_mul_f32 v26, v98, v98
    v_fma_f32 v25, v25, v19, v18
    v_mfma_f32_16x16x32_bf16 v[76:79], v[44:47], v[236:239], v[76:79]
    s_cmp_ge_u32 s28, 4
    s_cbranch_scc1 kc_skip_10
    s_add_u32 m0, s31, 73728
    s_add_u32 s38, s69, 221184
    buffer_load_dwordx4 v3, s[8:11], s38 offen lds
kc_skip_10:
    v_mul_f32 v24, v24, v96
    v_fmac_f32 v100, v32, v20
    v_mfma_f32_16x16x32_bf16 v[64:67], v[48:51], v[240:243], v[64:67]
    ds_read_b128 v[44:47], v3 offset:1024
    v_fmac_f32 v108, v36, v20
    buffer_store_dwordx4 v[12:15], v3, s[20:23], s35 offen offset:0 sc1
    v_mfma_f32_16x16x32_bf16 v[68:71], v[48:51], v[244:247], v[68:71]
    s_add_u32 m0, s36, 73728
    v_mul_f32 v27, v99, v99
    v_exp_f32 v24, v24
    v_mfma_f32_16x16x32_bf16 v[72:75], v[52:55], v[240:243], v[72:75]
    ds_read_b128 v[48:51], v3 offset:2048
    v_mul_f32 v96, v96, v104
    v_fma_f32 v26, v26, v19, v18
    v_mfma_f32_16x16x32_bf16 v[76:79], v[52:55], v[244:247], v[76:79]
    s_add_u32 s38, s68, 221184
    v_mul_f32 v25, v25, v97
    v_fmac_f32 v101, v33, v20
    v_mfma_f32_16x16x32_bf16 v[64:67], v[56:59], v[248:251], v[64:67]
    ds_read_b128 v[52:55], v3 offset:3072
    v_fmac_f32 v109, v37, v20
    v_mul_f32 v28, v100, v100
    v_mfma_f32_16x16x32_bf16 v[68:71], v[56:59], v[252:255], v[68:71]
    buffer_load_dwordx4 v3, s[8:11], s38 offen offset:0 lds
    v_exp_f32 v25, v25
    v_mul_f32 v97, v97, v105
    v_mfma_f32_16x16x32_bf16 v[72:75], v[60:63], v[248:251], v[72:75]
    ds_read_b128 v[56:59], v3 offset:4096
    v_fma_f32 v27, v27, v19, v18
    v_mul_f32 v26, v26, v98
    v_mfma_f32_16x16x32_bf16 v[76:79], v[60:63], v[252:255], v[76:79]
    buffer_load_dwordx4 v3, s[8:11], s38 offen offset:1024 lds
    v_fma_f32 v24, v24, v17, v17
    v_rcp_f32 v24, v24
    s_waitcnt lgkmcnt(3)
    v_mfma_f32_16x16x32_bf16 v[80:83], v[40:43], v[112:115], 0
    ds_read_b128 v[60:63], v3 offset:5120
    v_fmac_f32 v102, v34, v20
    v_mfma_f32_16x16x32_bf16 v[84:87], v[40:43], v[116:119], 0
    buffer_load_dwordx4 v3, s[8:11], s38 offen offset:2048 lds
    v_fmac_f32 v110, v38, v20
    v_mfma_f32_16x16x32_bf16 v[88:91], v[44:47], v[112:115], 0
    ds_read_b128 v[40:43], v3 offset:6144
    v_mul_f32 v29, v101, v101
    v_mfma_f32_16x16x32_bf16 v[92:95], v[44:47], v[116:119], 0
    buffer_load_dwordx4 v3, s[8:11], s38 offen offset:3072 lds
    v_exp_f32 v26, v26
    s_waitcnt lgkmcnt(3)
    v_mfma_f32_16x16x32_bf16 v[80:83], v[48:51], v[120:123], v[80:83]
    ds_read_b128 v[44:47], v3 offset:7168
    v_mul_f32 v98, v98, v106
    v_fma_f32 v28, v28, v23, v22
    v_mfma_f32_16x16x32_bf16 v[84:87], v[48:51], v[124:127], v[84:87]
    s_mov_b32 m0, s64
    s_nop 0
    buffer_load_dwordx4 v9, s[4:7], s34 offen lds
    s_add_u32 s34, s34, 32
    v_mul_f32 v27, v27, v99
    v_fma_f32 v25, v25, v17, v17
    v_mfma_f32_16x16x32_bf16 v[88:91], v[52:55], v[120:123], v[88:91]
    ds_read_b128 v[48:51], v3 offset:8192
    v_rcp_f32 v25, v25
    v_fmac_f32 v103, v35, v20
    v_mfma_f32_16x16x32_bf16 v[92:95], v[52:55], v[124:127], v[92:95]
    v_fmac_f32 v111, v39, v20
    v_mul_f32 v30, v102, v102
    s_waitcnt lgkmcnt(3)
    v_mfma_f32_16x16x32_bf16 v[80:83], v[56:59], v[128:131], v[80:83]
    ds_read_b128 v[52:55], v3 offset:9216
    v_mul_f32 v96, v96, v24
    v_exp_f32 v27, v27
    v_mfma_f32_16x16x32_bf16 v[84:87], v[56:59], v[132:135], v[84:87]
    v_mul_f32 v99, v99, v107
    v_fma_f32 v29, v29, v23, v22
    v_mfma_f32_16x16x32_bf16 v[88:91], v[60:63], v[128:131], v[88:91]
    ds_read_b128 v[56:59], v3 offset:10240
    v_mul_f32 v28, v28, v100
    v_fma_f32 v26, v26, v17, v17
    v_mfma_f32_16x16x32_bf16 v[92:95], v[60:63], v[132:135], v[92:95]
    ds_read_b128 v[32:35], v10 offset:192
    ds_read_b128 v[36:39], v10 offset:1216
    v_rcp_f32 v26, v26
    s_waitcnt lgkmcnt(5)
    v_mfma_f32_16x16x32_bf16 v[80:83], v[40:43], v[136:139], v[80:83]
    ds_read_b128 v[60:63], v3 offset:11264
    v_mul_f32 v31, v103, v103
    v_mul_f32 v97, v97, v25
    v_mfma_f32_16x16x32_bf16 v[84:87], v[40:43], v[140:143], v[84:87]
    v_exp_f32 v28, v28
    v_mul_f32 v100, v100, v108
    v_mfma_f32_16x16x32_bf16 v[88:91], v[44:47], v[136:139], v[88:91]
    ds_read_b128 v[40:43], v3 offset:12288
    v_fma_f32 v30, v30, v23, v22
    v_mul_f32 v29, v29, v101
    v_mfma_f32_16x16x32_bf16 v[92:95], v[44:47], v[140:143], v[92:95]
    v_fma_f32 v27, v27, v17, v17
    v_rcp_f32 v27, v27
    s_waitcnt lgkmcnt(5)
    v_mfma_f32_16x16x32_bf16 v[80:83], v[48:51], v[144:147], v[80:83]
    ds_read_b128 v[44:47], v3 offset:13312
    v_mul_f32 v98, v98, v26
    v_exp_f32 v29, v29
    v_mfma_f32_16x16x32_bf16 v[84:87], v[48:51], v[148:151], v[84:87]
    v_mul_f32 v101, v101, v109
    v_fma_f32 v31, v31, v23, v22
    v_mfma_f32_16x16x32_bf16 v[88:91], v[52:55], v[144:147], v[88:91]
    ds_read_b128 v[48:51], v3 offset:14336
    v_mul_f32 v30, v30, v102
    v_fma_f32 v28, v28, v21, v21
    v_mfma_f32_16x16x32_bf16 v[92:95], v[52:55], v[148:151], v[92:95]
    v_rcp_f32 v28, v28
    v_mul_f32 v99, v99, v27
    s_waitcnt lgkmcnt(3)
    v_mfma_f32_16x16x32_bf16 v[80:83], v[56:59], v[152:155], v[80:83]
    ds_read_b128 v[52:55], v3 offset:15360
    v_exp_f32 v30, v30
    v_mul_f32 v102, v102, v110
    v_mfma_f32_16x16x32_bf16 v[84:87], v[56:59], v[156:159], v[84:87]
    v_mul_f32 v31, v31, v103
    v_fma_f32 v29, v29, v21, v21
    v_mfma_f32_16x16x32_bf16 v[88:91], v[60:63], v[152:155], v[88:91]
    ds_read_b128 v[56:59], v3 offset:16384
    v_rcp_f32 v29, v29
    v_mul_f32 v100, v100, v28
    v_mfma_f32_16x16x32_bf16 v[92:95], v[60:63], v[156:159], v[92:95]
    v_exp_f32 v31, v31
    v_mul_f32 v103, v103, v111
    s_waitcnt lgkmcnt(3)
    v_mfma_f32_16x16x32_bf16 v[80:83], v[40:43], v[160:163], v[80:83]
    ds_read_b128 v[60:63], v3 offset:17408
    v_fma_f32 v30, v30, v21, v21
    v_rcp_f32 v30, v30
    v_mfma_f32_16x16x32_bf16 v[84:87], v[40:43], v[164:167], v[84:87]
    v_mul_f32 v101, v101, v29
    v_fma_f32 v31, v31, v21, v21
    v_mfma_f32_16x16x32_bf16 v[88:91], v[44:47], v[160:163], v[88:91]
    ds_read_b128 v[40:43], v3 offset:18432
    v_rcp_f32 v31, v31
    v_mul_f32 v102, v102, v30
    v_mfma_f32_16x16x32_bf16 v[92:95], v[44:47], v[164:167], v[92:95]
    s_nop 0
    v_mul_f32 v103, v103, v31
    s_waitcnt lgkmcnt(3)
    v_mfma_f32_16x16x32_bf16 v[80:83], v[48:51], v[168:171], v[80:83]
    ds_read_b128 v[44:47], v3 offset:19456
    v_cvt_pk_bf16_f32 v24, v96, v97
    v_cvt_pk_bf16_f32 v25, v98, v99
    v_mfma_f32_16x16x32_bf16 v[84:87], v[48:51], v[172:175], v[84:87]
    v_cvt_pk_bf16_f32 v26, v100, v101
    v_cvt_pk_bf16_f32 v27, v102, v103
    v_mfma_f32_16x16x32_bf16 v[88:91], v[52:55], v[168:171], v[88:91]
    ds_read_b128 v[48:51], v3 offset:20480
    s_add_u32 s43, s42, 131072
    s_nop 0
    v_mfma_f32_16x16x32_bf16 v[92:95], v[52:55], v[172:175], v[92:95]
    v_permlane16_swap_b32 v24, v26
    v_permlane16_swap_b32 v25, v27
    s_waitcnt lgkmcnt(3)
    v_mfma_f32_16x16x32_bf16 v[80:83], v[56:59], v[176:179], v[80:83]
    ds_read_b128 v[52:55], v3 offset:21504
    buffer_store_dwordx4 v[24:27], v1, s[16:19], s43 offen sc1
    s_nop 0
    v_mfma_f32_16x16x32_bf16 v[84:87], v[56:59], v[180:183], v[84:87]
    v_fmac_f32 v64, v32, v16
    v_mfma_f32_16x16x32_bf16 v[88:91], v[60:63], v[176:179], v[88:91]
    ds_read_b128 v[56:59], v3 offset:22528
    v_fmac_f32 v72, v36, v16
    v_fmac_f32 v65, v33, v16
    v_mfma_f32_16x16x32_bf16 v[92:95], v[60:63], v[180:183], v[92:95]
    v_fmac_f32 v73, v37, v16
    v_mul_f32 v24, v64, v64
    s_waitcnt lgkmcnt(3)
    v_mfma_f32_16x16x32_bf16 v[80:83], v[40:43], v[184:187], v[80:83]
    ds_read_b128 v[60:63], v3 offset:23552
    v_fmac_f32 v66, v34, v16
    v_fmac_f32 v74, v38, v16
    v_mfma_f32_16x16x32_bf16 v[84:87], v[40:43], v[188:191], v[84:87]
    v_mul_f32 v25, v65, v65
    v_fma_f32 v24, v24, v19, v18
    v_mfma_f32_16x16x32_bf16 v[88:91], v[44:47], v[184:187], v[88:91]
    ds_read_b128 v[40:43], v3 offset:24576
    v_fmac_f32 v67, v35, v16
    v_fmac_f32 v75, v39, v16
    v_mfma_f32_16x16x32_bf16 v[92:95], v[44:47], v[188:191], v[92:95]
    v_mul_f32 v26, v66, v66
    v_fma_f32 v25, v25, v19, v18
    s_waitcnt lgkmcnt(3)
    v_mfma_f32_16x16x32_bf16 v[80:83], v[48:51], v[192:195], v[80:83]
    ds_read_b128 v[44:47], v3 offset:25600
    s_waitcnt vmcnt(1)
    ds_read_b64_tr_b16 v[12:13], v11
    ds_read_b64_tr_b16 v[14:15], v11 offset:128
    v_mul_f32 v24, v24, v64
    v_mfma_f32_16x16x32_bf16 v[84:87], v[48:51], v[196:199], v[84:87]
    v_fmac_f32 v68, v32, v20
    v_fmac_f32 v76, v36, v20
    v_mfma_f32_16x16x32_bf16 v[88:91], v[52:55], v[192:195], v[88:91]
    ds_read_b128 v[48:51], v3 offset:26624
    v_mul_f32 v27, v67, v67
    v_exp_f32 v24, v24
    v_mfma_f32_16x16x32_bf16 v[92:95], v[52:55], v[196:199], v[92:95]
    v_mul_f32 v64, v64, v72
    v_fma_f32 v26, v26, v19, v18
    s_waitcnt lgkmcnt(5)
    v_mfma_f32_16x16x32_bf16 v[80:83], v[56:59], v[200:203], v[80:83]
    ds_read_b128 v[52:55], v3 offset:27648
    v_mul_f32 v25, v25, v65
    s_waitcnt lgkmcnt(2)
    buffer_store_dwordx4 v[12:15], v3, s[20:23], s35 offen offset:1024 sc1
    v_mfma_f32_16x16x32_bf16 v[84:87], v[56:59], v[204:207], v[84:87]
    s_mov_b32 m0, s64
    s_nop 0
    buffer_load_dwordx4 v9, s[4:7], s34 offen lds
    s_add_u32 s34, s34, 32
    v_fmac_f32 v69, v33, v20
    v_fmac_f32 v77, v37, v20
    v_mfma_f32_16x16x32_bf16 v[88:91], v[60:63], v[200:203], v[88:91]
    ds_read_b128 v[56:59], v3 offset:28672
    v_mul_f32 v28, v68, v68
    v_exp_f32 v25, v25
    v_mfma_f32_16x16x32_bf16 v[92:95], v[60:63], v[204:207], v[92:95]
    v_mul_f32 v65, v65, v73
    v_fma_f32 v27, v27, v19, v18
    v_mfma_f32_16x16x32_bf16 v[80:83], v[40:43], v[208:211], v[80:83]
    ds_read_b128 v[60:63], v3 offset:29696
    v_mul_f32 v26, v26, v66
    v_fma_f32 v24, v24, v17, v17
    v_mfma_f32_16x16x32_bf16 v[84:87], v[40:43], v[212:215], v[84:87]
    v_rcp_f32 v24, v24
    v_fmac_f32 v70, v34, v20
    v_mfma_f32_16x16x32_bf16 v[88:91], v[44:47], v[208:211], v[88:91]
    ds_read_b128 v[40:43], v3 offset:30720
    v_fmac_f32 v78, v38, v20
    v_mul_f32 v29, v69, v69
    v_mfma_f32_16x16x32_bf16 v[92:95], v[44:47], v[212:215], v[92:95]
    v_exp_f32 v26, v26
    v_mul_f32 v66, v66, v74
    s_waitcnt lgkmcnt(3)
    v_mfma_f32_16x16x32_bf16 v[80:83], v[48:51], v[216:219], v[80:83]
    ds_read_b128 v[44:47], v3 offset:31744
    v_fma_f32 v28, v28, v23, v22
    v_mul_f32 v27, v27, v67
    v_mfma_f32_16x16x32_bf16 v[84:87], v[48:51], v[220:223], v[84:87]
    v_fma_f32 v25, v25, v17, v17
    v_rcp_f32 v25, v25
    v_mfma_f32_16x16x32_bf16 v[88:91], v[52:55], v[216:219], v[88:91]
    ds_read_b128 v[48:51], v3 offset:32768
    v_fmac_f32 v71, v35, v20
    v_fmac_f32 v79, v39, v20
    v_mfma_f32_16x16x32_bf16 v[92:95], v[52:55], v[220:223], v[92:95]
    v_mul_f32 v30, v70, v70
    v_mul_f32 v64, v64, v24
    s_waitcnt lgkmcnt(3)
    v_mfma_f32_16x16x32_bf16 v[80:83], v[56:59], v[224:227], v[80:83]
    ds_read_b128 v[52:55], v3 offset:33792
    v_exp_f32 v27, v27
    v_mul_f32 v67, v67, v75
    v_mfma_f32_16x16x32_bf16 v[84:87], v[56:59], v[228:231], v[84:87]
    v_fma_f32 v29, v29, v23, v22
    v_mul_f32 v28, v28, v68
    v_mfma_f32_16x16x32_bf16 v[88:91], v[60:63], v[224:227], v[88:91]
    ds_read_b128 v[56:59], v3 offset:34816
    v_fma_f32 v26, v26, v17, v17
    ds_read_b128 v[32:35], v10 offset:256
    ds_read_b128 v[36:39], v10 offset:1280
    v_mfma_f32_16x16x32_bf16 v[92:95], v[60:63], v[228:231], v[92:95]
    v_rcp_f32 v26, v26
    v_mul_f32 v31, v71, v71
    s_waitcnt lgkmcnt(5)
    v_mfma_f32_16x16x32_bf16 v[80:83], v[40:43], v[232:235], v[80:83]
    ds_read_b128 v[60:63], v3 offset:35840
    v_mul_f32 v65, v65, v25
    v_exp_f32 v28, v28
    v_mfma_f32_16x16x32_bf16 v[84:87], v[40:43], v[236:239], v[84:87]
    v_mul_f32 v68, v68, v76
    v_fma_f32 v30, v30, v23, v22
    v_mfma_f32_16x16x32_bf16 v[88:91], v[44:47], v[232:235], v[88:91]
    s_waitcnt lgkmcnt(0)
    s_barrier
    ds_read_b128 v[40:43], v6 offset:0
    v_mul_f32 v29, v29, v69
    v_fma_f32 v27, v27, v17, v17
    v_mfma_f32_16x16x32_bf16 v[92:95], v[44:47], v[236:239], v[92:95]
    s_cmp_ge_u32 s28, 4
    s_cbranch_scc1 kc_skip_11
    s_add_u32 m0, s31, 110592
    s_add_u32 s38, s69, 258048
    buffer_load_dwordx4 v3, s[8:11], s38 offen lds
kc_skip_11:
    v_rcp_f32 v27, v27
    v_mul_f32 v66, v66, v26
    v_mfma_f32_16x16x32_bf16 v[80:83], v[48:51], v[240:243], v[80:83]
    ds_read_b128 v[44:47], v6 offset:1024
    v_exp_f32 v29, v29
    v_mul_f32 v69, v69, v77
    v_mfma_f32_16x16x32_bf16 v[84:87], v[48:51], v[244:247], v[84:87]
    s_add_u32 m0, s36, 110592
    v_fma_f32 v31, v31, v23, v22
    v_mul_f32 v30, v30, v70
    v_mfma_f32_16x16x32_bf16 v[88:91], v[52:55], v[240:243], v[88:91]
    ds_read_b128 v[48:51], v6 offset:2048
    v_fma_f32 v28, v28, v21, v21
    v_rcp_f32 v28, v28
    v_mfma_f32_16x16x32_bf16 v[92:95], v[52:55], v[244:247], v[92:95]
    s_add_u32 s38, s68, 258048
    v_mul_f32 v67, v67, v27
    v_exp_f32 v30, v30
    v_mfma_f32_16x16x32_bf16 v[80:83], v[56:59], v[248:251], v[80:83]
    ds_read_b128 v[52:55], v6 offset:3072
    v_mul_f32 v70, v70, v78
    v_mul_f32 v31, v31, v71
    v_mfma_f32_16x16x32_bf16 v[84:87], v[56:59], v[252:255], v[84:87]
    buffer_load_dwordx4 v3, s[8:11], s38 offen offset:0 lds
    v_fma_f32 v29, v29, v21, v21
    v_rcp_f32 v29, v29
    v_mfma_f32_16x16x32_bf16 v[88:91], v[60:63], v[248:251], v[88:91]
    ds_read_b128 v[56:59], v6 offset:4096
    v_mul_f32 v68, v68, v28
    v_exp_f32 v31, v31
    v_mfma_f32_16x16x32_bf16 v[92:95], v[60:63], v[252:255], v[92:95]
    buffer_load_dwordx4 v3, s[8:11], s38 offen offset:1024 lds
    v_mul_f32 v71, v71, v79
    v_fma_f32 v30, v30, v21, v21
    s_waitcnt lgkmcnt(3)
    v_mfma_f32_16x16x32_bf16 v[96:99], v[40:43], v[112:115], 0
    ds_read_b128 v[60:63], v6 offset:5120
    v_rcp_f32 v30, v30
    v_mfma_f32_16x16x32_bf16 v[100:103], v[40:43], v[116:119], 0
    buffer_load_dwordx4 v3, s[8:11], s38 offen offset:2048 lds
    v_mul_f32 v69, v69, v29
    v_mfma_f32_16x16x32_bf16 v[104:107], v[44:47], v[112:115], 0
    ds_read_b128 v[40:43], v6 offset:6144
    v_fma_f32 v31, v31, v21, v21
    v_mfma_f32_16x16x32_bf16 v[108:111], v[44:47], v[116:119], 0
    buffer_load_dwordx4 v3, s[8:11], s38 offen offset:3072 lds
    v_rcp_f32 v31, v31
    s_waitcnt lgkmcnt(3)
    v_mfma_f32_16x16x32_bf16 v[96:99], v[48:51], v[120:123], v[96:99]
    ds_read_b128 v[44:47], v6 offset:7168
    v_mul_f32 v70, v70, v30
    s_nop 0
    v_mfma_f32_16x16x32_bf16 v[100:103], v[48:51], v[124:127], v[100:103]
    v_mul_f32 v71, v71, v31
    v_cvt_pk_bf16_f32 v24, v64, v65
    v_mfma_f32_16x16x32_bf16 v[104:107], v[52:55], v[120:123], v[104:107]
    ds_read_b128 v[48:51], v6 offset:8192
    v_cvt_pk_bf16_f32 v25, v66, v67
    v_cvt_pk_bf16_f32 v26, v68, v69
    v_mfma_f32_16x16x32_bf16 v[108:111], v[52:55], v[124:127], v[108:111]
    v_cvt_pk_bf16_f32 v27, v70, v71
    s_add_u32 s43, s42, 196608
    s_waitcnt lgkmcnt(3)
    v_mfma_f32_16x16x32_bf16 v[96:99], v[56:59], v[128:131], v[96:99]
    ds_read_b128 v[52:55], v6 offset:9216
    s_nop 0
    v_permlane16_swap_b32 v24, v26
    v_mfma_f32_16x16x32_bf16 v[100:103], v[56:59], v[132:135], v[100:103]
    v_permlane16_swap_b32 v25, v27
    buffer_store_dwordx4 v[24:27], v1, s[16:19], s43 offen sc1
    v_mfma_f32_16x16x32_bf16 v[104:107], v[60:63], v[128:131], v[104:107]
    ds_read_b128 v[56:59], v6 offset:10240
    s_nop 0
    v_mfma_f32_16x16x32_bf16 v[108:111], v[60:63], v[132:135], v[108:111]
    v_fmac_f32 v80, v32, v16
    v_fmac_f32 v88, v36, v16
    s_waitcnt lgkmcnt(3)
    v_mfma_f32_16x16x32_bf16 v[96:99], v[40:43], v[136:139], v[96:99]
    ds_read_b128 v[60:63], v6 offset:11264
    v_fmac_f32 v81, v33, v16
    v_fmac_f32 v89, v37, v16
    v_mfma_f32_16x16x32_bf16 v[100:103], v[40:43], v[140:143], v[100:103]
    v_mul_f32 v24, v80, v80
    v_fmac_f32 v82, v34, v16
    v_mfma_f32_16x16x32_bf16 v[104:107], v[44:47], v[136:139], v[104:107]
    ds_read_b128 v[40:43], v6 offset:12288
    v_fmac_f32 v90, v38, v16
    v_mul_f32 v25, v81, v81
    v_mfma_f32_16x16x32_bf16 v[108:111], v[44:47], v[140:143], v[108:111]
    v_fma_f32 v24, v24, v19, v18
    v_fmac_f32 v83, v35, v16
    s_waitcnt lgkmcnt(3)
    v_mfma_f32_16x16x32_bf16 v[96:99], v[48:51], v[144:147], v[96:99]
    ds_read_b128 v[44:47], v6 offset:13312
    v_fmac_f32 v91, v39, v16
    v_mul_f32 v26, v82, v82
    v_mfma_f32_16x16x32_bf16 v[100:103], v[48:51], v[148:151], v[100:103]
    v_fma_f32 v25, v25, v19, v18
    v_mul_f32 v24, v24, v80
    v_mfma_f32_16x16x32_bf16 v[104:107], v[52:55], v[144:147], v[104:107]
    ds_read_b128 v[48:51], v6 offset:14336
    v_fmac_f32 v84, v32, v20
    v_fmac_f32 v92, v36, v20
    v_mfma_f32_16x16x32_bf16 v[108:111], v[52:55], v[148:151], v[108:111]
    v_mul_f32 v27, v83, v83
    v_exp_f32 v24, v24
    s_waitcnt lgkmcnt(3)
    v_mfma_f32_16x16x32_bf16 v[96:99], v[56:59], v[152:155], v[96:99]
    ds_read_b128 v[52:55], v6 offset:15360
    s_waitcnt vmcnt(5)
    ds_read_b64_tr_b16 v[12:13], v11
    ds_read_b64_tr_b16 v[14:15], v11 offset:128
    v_mul_f32 v80, v80, v88
    v_mfma_f32_16x16x32_bf16 v[100:103], v[56:59], v[156:159], v[100:103]
    v_fma_f32 v26, v26, v19, v18
    v_mul_f32 v25, v25, v81
    v_mfma_f32_16x16x32_bf16 v[104:107], v[60:63], v[152:155], v[104:107]
    ds_read_b128 v[56:59], v6 offset:16384
    v_fmac_f32 v85, v33, v20
    v_fmac_f32 v93, v37, v20
    v_mfma_f32_16x16x32_bf16 v[108:111], v[60:63], v[156:159], v[108:111]
    v_mul_f32 v28, v84, v84
    v_exp_f32 v25, v25
    s_waitcnt lgkmcnt(5)
    v_mfma_f32_16x16x32_bf16 v[96:99], v[40:43], v[160:163], v[96:99]
    ds_read_b128 v[60:63], v6 offset:17408
    v_mul_f32 v81, v81, v89
    s_waitcnt lgkmcnt(2)
    buffer_store_dwordx4 v[12:15], v3, s[20:23], s35 offen offset:2048 sc1
    v_mfma_f32_16x16x32_bf16 v[100:103], v[40:43], v[164:167], v[100:103]
    v_fma_f32 v27, v27, v19, v18
    v_mul_f32 v26, v26, v82
    v_mfma_f32_16x16x32_bf16 v[104:107], v[44:47], v[160:163], v[104:107]
    ds_read_b128 v[40:43], v6 offset:18432
    v_fma_f32 v24, v24, v17, v17
    v_rcp_f32 v24, v24
    v_mfma_f32_16x16x32_bf16 v[108:111], v[44:47], v[164:167], v[108:111]
    v_fmac_f32 v86, v34, v20
    v_fmac_f32 v94, v38, v20
    v_mfma_f32_16x16x32_bf16 v[96:99], v[48:51], v[168:171], v[96:99]
    ds_read_b128 v[44:47], v6 offset:19456
    v_mul_f32 v29, v85, v85
    v_exp_f32 v26, v26
    v_mfma_f32_16x16x32_bf16 v[100:103], v[48:51], v[172:175], v[100:103]
    v_mul_f32 v82, v82, v90
    v_fma_f32 v28, v28, v23, v22
    v_mfma_f32_16x16x32_bf16 v[104:107], v[52:55], v[168:171], v[104:107]
    ds_read_b128 v[48:51], v6 offset:20480
    v_mul_f32 v27, v27, v83
    v_fma_f32 v25, v25, v17, v17
    v_mfma_f32_16x16x32_bf16 v[108:111], v[52:55], v[172:175], v[108:111]
    v_rcp_f32 v25, v25
    v_fmac_f32 v87, v35, v20
    s_waitcnt lgkmcnt(3)
    v_mfma_f32_16x16x32_bf16 v[96:99], v[56:59], v[176:179], v[96:99]
    ds_read_b128 v[52:55], v6 offset:21504
    v_fmac_f32 v95, v39, v20
    v_mul_f32 v30, v86, v86
    v_mfma_f32_16x16x32_bf16 v[100:103], v[56:59], v[180:183], v[100:103]
    v_mul_f32 v80, v80, v24
    v_exp_f32 v27, v27
    v_mfma_f32_16x16x32_bf16 v[104:107], v[60:63], v[176:179], v[104:107]
    ds_read_b128 v[56:59], v6 offset:22528
    v_mul_f32 v83, v83, v91
    v_fma_f32 v29, v29, v23, v22
    v_mfma_f32_16x16x32_bf16 v[108:111], v[60:63], v[180:183], v[108:111]
    v_mul_f32 v28, v28, v84
    v_fma_f32 v26, v26, v17, v17
    s_waitcnt lgkmcnt(3)
    v_mfma_f32_16x16x32_bf16 v[96:99], v[40:43], v[184:187], v[96:99]
    ds_read_b128 v[60:63], v6 offset:23552
    ds_read_b128 v[32:35], v10 offset:320
    ds_read_b128 v[36:39], v10 offset:1344
    v_rcp_f32 v26, v26
    v_mfma_f32_16x16x32_bf16 v[100:103], v[40:43], v[188:191], v[100:103]
    v_mul_f32 v31, v87, v87
    v_mul_f32 v81, v81, v25
    v_mfma_f32_16x16x32_bf16 v[104:107], v[44:47], v[184:187], v[104:107]
    ds_read_b128 v[40:43], v6 offset:24576
    v_exp_f32 v28, v28
    v_mul_f32 v84, v84, v92
    v_mfma_f32_16x16x32_bf16 v[108:111], v[44:47], v[188:191], v[108:111]
    v_fma_f32 v30, v30, v23, v22
    v_mul_f32 v29, v29, v85
    s_waitcnt lgkmcnt(5)
    v_mfma_f32_16x16x32_bf16 v[96:99], v[48:51], v[192:195], v[96:99]
    ds_read_b128 v[44:47], v6 offset:25600
    v_fma_f32 v27, v27, v17, v17
    v_rcp_f32 v27, v27
    v_mfma_f32_16x16x32_bf16 v[100:103], v[48:51], v[196:199], v[100:103]
    v_mul_f32 v82, v82, v26
    v_exp_f32 v29, v29
    v_mfma_f32_16x16x32_bf16 v[104:107], v[52:55], v[192:195], v[104:107]
    ds_read_b128 v[48:51], v6 offset:26624
    v_mul_f32 v85, v85, v93
    v_fma_f32 v31, v31, v23, v22
    v_mfma_f32_16x16x32_bf16 v[108:111], v[52:55], v[196:199], v[108:111]
    v_mul_f32 v30, v30, v86
    v_fma_f32 v28, v28, v21, v21
    s_waitcnt lgkmcnt(5)
    v_mfma_f32_16x16x32_bf16 v[96:99], v[56:59], v[200:203], v[96:99]
    ds_read_b128 v[52:55], v6 offset:27648
    v_rcp_f32 v28, v28
    v_mul_f32 v83, v83, v27
    v_mfma_f32_16x16x32_bf16 v[100:103], v[56:59], v[204:207], v[100:103]
    v_exp_f32 v30, v30
    v_mul_f32 v86, v86, v94
    v_mfma_f32_16x16x32_bf16 v[104:107], v[60:63], v[200:203], v[104:107]
    ds_read_b128 v[56:59], v6 offset:28672
    v_mul_f32 v31, v31, v87
    v_fma_f32 v29, v29, v21, v21
    v_mfma_f32_16x16x32_bf16 v[108:111], v[60:63], v[204:207], v[108:111]
    v_rcp_f32 v29, v29
    v_mul_f32 v84, v84, v28
    s_waitcnt lgkmcnt(3)
    v_mfma_f32_16x16x32_bf16 v[96:99], v[40:43], v[208:211], v[96:99]
    ds_read_b128 v[60:63], v6 offset:29696
    v_exp_f32 v31, v31
    v_mul_f32 v87, v87, v95
    v_mfma_f32_16x16x32_bf16 v[100:103], v[40:43], v[212:215], v[100:103]
    v_fma_f32 v30, v30, v21, v21
    v_rcp_f32 v30, v30
    v_mfma_f32_16x16x32_bf16 v[104:107], v[44:47], v[208:211], v[104:107]
    ds_read_b128 v[40:43], v6 offset:30720
    v_mul_f32 v85, v85, v29
    v_mfma_f32_16x16x32_bf16 v[108:111], v[44:47], v[212:215], v[108:111]
    v_fma_f32 v31, v31, v21, v21
    s_waitcnt lgkmcnt(3)
    v_mfma_f32_16x16x32_bf16 v[96:99], v[48:51], v[216:219], v[96:99]
    ds_read_b128 v[44:47], v6 offset:31744
    v_rcp_f32 v31, v31
    v_mfma_f32_16x16x32_bf16 v[100:103], v[48:51], v[220:223], v[100:103]
    v_mul_f32 v86, v86, v30
    v_mfma_f32_16x16x32_bf16 v[104:107], v[52:55], v[216:219], v[104:107]
    ds_read_b128 v[48:51], v6 offset:32768
    s_nop 0
    v_mfma_f32_16x16x32_bf16 v[108:111], v[52:55], v[220:223], v[108:111]
    v_mul_f32 v87, v87, v31
    s_waitcnt lgkmcnt(3)
    v_mfma_f32_16x16x32_bf16 v[96:99], v[56:59], v[224:227], v[96:99]
    ds_read_b128 v[52:55], v6 offset:33792
    v_cvt_pk_bf16_f32 v24, v80, v81
    v_mfma_f32_16x16x32_bf16 v[100:103], v[56:59], v[228:231], v[100:103]
    v_cvt_pk_bf16_f32 v25, v82, v83
    v_mfma_f32_16x16x32_bf16 v[104:107], v[60:63], v[224:227], v[104:107]
    ds_read_b128 v[56:59], v6 offset:34816
    v_cvt_pk_bf16_f32 v26, v84, v85
    v_mfma_f32_16x16x32_bf16 v[108:111], v[60:63], v[228:231], v[108:111]
    v_cvt_pk_bf16_f32 v27, v86, v87
    s_waitcnt lgkmcnt(3)
    v_mfma_f32_16x16x32_bf16 v[96:99], v[40:43], v[232:235], v[96:99]
    ds_read_b128 v[60:63], v6 offset:35840
    s_add_u32 s43, s42, 262144
    v_mfma_f32_16x16x32_bf16 v[100:103], v[40:43], v[236:239], v[100:103]
    s_nop 0
    v_mfma_f32_16x16x32_bf16 v[104:107], v[44:47], v[232:235], v[104:107]
    s_waitcnt lgkmcnt(0)
    s_waitcnt vmcnt(0)
    s_barrier
    v_mov_b32 v4, 4
    v_mov_b32 v5, 0
    s_mov_b64 exec, 1
    buffer_store_dword v4, v5, s[60:63], s55 offen sc1
    s_mov_b64 exec, -1
    s_cmp_lg_u32 s28, 0
    s_cbranch_scc1 kc_pkf_12
    v_mov_b32 v4, 15
    s_mov_b64 exec, 1
    buffer_store_dword v4, v5, s[60:63], s33 offen sc1
    s_mov_b64 exec, -1
kc_pkf_12:
    ds_read_b128 v[40:43], v7 offset:0
    v_permlane16_swap_b32 v24, v26
    v_mfma_f32_16x16x32_bf16 v[108:111], v[44:47], v[236:239], v[108:111]
    s_cmp_ge_u32 s28, 4
    s_cbranch_scc1 kc_skip_13
    s_add_u32 m0, s31, 0
    s_add_u32 s38, s69, 294912
    buffer_load_dwordx4 v3, s[8:11], s38 offen lds
kc_skip_13:
    v_permlane16_swap_b32 v25, v27
    v_mfma_f32_16x16x32_bf16 v[96:99], v[48:51], v[240:243], v[96:99]
    ds_read_b128 v[44:47], v7 offset:1024
    buffer_store_dwordx4 v[24:27], v1, s[16:19], s43 offen sc1
    v_mfma_f32_16x16x32_bf16 v[100:103], v[48:51], v[244:247], v[100:103]
    s_add_u32 m0, s36, 0
    s_nop 0
    v_mfma_f32_16x16x32_bf16 v[104:107], v[52:55], v[240:243], v[104:107]
    ds_read_b128 v[48:51], v7 offset:2048
    v_mfma_f32_16x16x32_bf16 v[108:111], v[52:55], v[244:247], v[108:111]
    s_add_u32 s38, s68, 294912
    v_mfma_f32_16x16x32_bf16 v[96:99], v[56:59], v[248:251], v[96:99]
    ds_read_b128 v[52:55], v7 offset:3072
    v_mfma_f32_16x16x32_bf16 v[100:103], v[56:59], v[252:255], v[100:103]
    buffer_load_dwordx4 v3, s[8:11], s38 offen offset:0 lds
    v_mfma_f32_16x16x32_bf16 v[104:107], v[60:63], v[248:251], v[104:107]
    ds_read_b128 v[56:59], v7 offset:4096
    v_mfma_f32_16x16x32_bf16 v[108:111], v[60:63], v[252:255], v[108:111]
    buffer_load_dwordx4 v3, s[8:11], s38 offen offset:1024 lds
    s_waitcnt lgkmcnt(3)
    v_mfma_f32_16x16x32_bf16 v[64:67], v[40:43], v[112:115], 0
    ds_read_b128 v[60:63], v7 offset:5120
    v_mfma_f32_16x16x32_bf16 v[68:71], v[40:43], v[116:119], 0
    buffer_load_dwordx4 v3, s[8:11], s38 offen offset:2048 lds
    v_mfma_f32_16x16x32_bf16 v[72:75], v[44:47], v[112:115], 0
    ds_read_b128 v[40:43], v7 offset:6144
    v_mfma_f32_16x16x32_bf16 v[76:79], v[44:47], v[116:119], 0
    buffer_load_dwordx4 v3, s[8:11], s38 offen offset:3072 lds
    s_waitcnt lgkmcnt(3)
    v_mfma_f32_16x16x32_bf16 v[64:67], v[48:51], v[120:123], v[64:67]
    ds_read_b128 v[44:47], v7 offset:7168
    v_fmac_f32 v96, v32, v16
    v_mfma_f32_16x16x32_bf16 v[68:71], v[48:51], v[124:127], v[68:71]
    v_fmac_f32 v104, v36, v16
    v_fmac_f32 v97, v33, v16
    v_mfma_f32_16x16x32_bf16 v[72:75], v[52:55], v[120:123], v[72:75]
    ds_read_b128 v[48:51], v7 offset:8192
    v_fmac_f32 v105, v37, v16
    v_mul_f32 v24, v96, v96
    v_mfma_f32_16x16x32_bf16 v[76:79], v[52:55], v[124:127], v[76:79]
    v_fmac_f32 v98, v34, v16
    v_fmac_f32 v106, v38, v16
    s_waitcnt lgkmcnt(3)
    v_mfma_f32_16x16x32_bf16 v[64:67], v[56:59], v[128:131], v[64:67]
    ds_read_b128 v[52:55], v7 offset:9216
    v_and_b32 v4, 7, v2
    v_bfe_u32 v5, v2, 3, 2
    v_mfma_f32_16x16x32_bf16 v[68:71], v[56:59], v[132:135], v[68:71]
    v_lshlrev_b32 v5, 5, v5
    v_add_u32 v4, v4, v5
    v_mfma_f32_16x16x32_bf16 v[72:75], v[60:63], v[128:131], v[72:75]
    ds_read_b128 v[56:59], v7 offset:10240
    v_lshlrev_b32 v4, 2, v4
    v_add_u32 v4, s71, v4
    v_mfma_f32_16x16x32_bf16 v[76:79], v[60:63], v[132:135], v[76:79]
    v_and_b32 v5, 15, v2
    v_lshlrev_b32 v5, 2, v5
    s_waitcnt lgkmcnt(3)
    v_mfma_f32_16x16x32_bf16 v[64:67], v[40:43], v[136:139], v[64:67]
    ds_read_b128 v[60:63], v7 offset:11264
    v_add_u32 v5, s32, v5
    v_cmp_gt_u32 vcc, 32, v2
    v_mfma_f32_16x16x32_bf16 v[68:71], v[40:43], v[140:143], v[68:71]
    s_nop 1
    v_cndmask_b32 v12, v5, v4, vcc
    v_mfma_f32_16x16x32_bf16 v[72:75], v[44:47], v[136:139], v[72:75]
    ds_read_b128 v[40:43], v7 offset:12288
    s_lshl_b32 s24, s54, 6
    s_lshl_b32 s25, s53, 2
    v_mfma_f32_16x16x32_bf16 v[76:79], v[44:47], v[140:143], v[76:79]
    s_add_u32 s24, s24, s25
    s_add_u32 s24, s24, 9445376
    s_waitcnt lgkmcnt(3)
    v_mfma_f32_16x16x32_bf16 v[64:67], v[48:51], v[144:147], v[64:67]
    ds_read_b128 v[44:47], v7 offset:13312
    v_and_b32 v4, 3, v2
    v_lshlrev_b32 v4, 8, v4
    v_mfma_f32_16x16x32_bf16 v[68:71], v[48:51], v[148:151], v[68:71]
    v_add_u32 v4, s24, v4
    v_cmp_gt_u32 vcc, 48, v2
    v_mfma_f32_16x16x32_bf16 v[72:75], v[52:55], v[144:147], v[72:75]
    ds_read_b128 v[48:51], v7 offset:14336
    s_nop 1
    v_cndmask_b32 v12, v4, v12, vcc
    v_mfma_f32_16x16x32_bf16 v[76:79], v[52:55], v[148:151], v[76:79]
    v_mul_f32 v25, v97, v97
    v_fma_f32 v24, v24, v19, v18
    s_waitcnt lgkmcnt(3)
    v_mfma_f32_16x16x32_bf16 v[64:67], v[56:59], v[152:155], v[64:67]
    ds_read_b128 v[52:55], v7 offset:15360
    v_fmac_f32 v99, v35, v16
    v_fmac_f32 v107, v39, v16
    v_mfma_f32_16x16x32_bf16 v[68:71], v[56:59], v[156:159], v[68:71]
    v_mul_f32 v26, v98, v98
    v_fma_f32 v25, v25, v19, v18
    v_mfma_f32_16x16x32_bf16 v[72:75], v[60:63], v[152:155], v[72:75]
    ds_read_b128 v[56:59], v7 offset:16384
    v_mul_f32 v24, v24, v96
    v_fmac_f32 v100, v32, v20
    v_mfma_f32_16x16x32_bf16 v[76:79], v[60:63], v[156:159], v[76:79]
    v_fmac_f32 v108, v36, v20
    v_mul_f32 v27, v99, v99
    s_waitcnt lgkmcnt(3)
    v_mfma_f32_16x16x32_bf16 v[64:67], v[40:43], v[160:163], v[64:67]
    ds_read_b128 v[60:63], v7 offset:17408
    v_exp_f32 v24, v24
    v_mul_f32 v96, v96, v104
    v_mfma_f32_16x16x32_bf16 v[68:71], v[40:43], v[164:167], v[68:71]
    v_fma_f32 v26, v26, v19, v18
    v_mul_f32 v25, v25, v97
    v_mfma_f32_16x16x32_bf16 v[72:75], v[44:47], v[160:163], v[72:75]
    ds_read_b128 v[40:43], v7 offset:18432
    v_fmac_f32 v101, v33, v20
    v_fmac_f32 v109, v37, v20
    v_mfma_f32_16x16x32_bf16 v[76:79], v[44:47], v[164:167], v[76:79]
    v_mul_f32 v28, v100, v100
    v_exp_f32 v25, v25
    s_waitcnt lgkmcnt(3)
    v_mfma_f32_16x16x32_bf16 v[64:67], v[48:51], v[168:171], v[64:67]
    ds_read_b128 v[44:47], v7 offset:19456
    v_mul_f32 v97, v97, v105
    v_fma_f32 v27, v27, v19, v18
    v_mfma_f32_16x16x32_bf16 v[68:71], v[48:51], v[172:175], v[68:71]
    v_mul_f32 v26, v26, v98
    v_fma_f32 v24, v24, v17, v17
    v_mfma_f32_16x16x32_bf16 v[72:75], v[52:55], v[168:171], v[72:75]
    ds_read_b128 v[48:51], v7 offset:20480
    v_rcp_f32 v24, v24
    v_fmac_f32 v102, v34, v20
    v_mfma_f32_16x16x32_bf16 v[76:79], v[52:55], v[172:175], v[76:79]
    v_fmac_f32 v110, v38, v20
    v_mul_f32 v29, v101, v101
    s_waitcnt lgkmcnt(3)
    v_mfma_f32_16x16x32_bf16 v[64:67], v[56:59], v[176:179], v[64:67]
    ds_read_b128 v[52:55], v7 offset:21504
    v_exp_f32 v26, v26
    v_mul_f32 v98, v98, v106
    v_mfma_f32_16x16x32_bf16 v[68:71], v[56:59], v[180:183], v[68:71]
    v_fma_f32 v28, v28, v23, v22
    v_mul_f32 v27, v27, v99
    v_mfma_f32_16x16x32_bf16 v[72:75], v[60:63], v[176:179], v[72:75]
    ds_read_b128 v[56:59], v7 offset:22528
    v_fma_f32 v25, v25, v17, v17
    v_rcp_f32 v25, v25
    v_mfma_f32_16x16x32_bf16 v[76:79], v[60:63], v[180:183], v[76:79]
    v_fmac_f32 v103, v35, v20
    v_fmac_f32 v111, v39, v20
    s_waitcnt lgkmcnt(3)
    v_mfma_f32_16x16x32_bf16 v[64:67], v[40:43], v[184:187], v[64:67]
    ds_read_b128 v[60:63], v7 offset:23552
    v_mul_f32 v30, v102, v102
    v_mul_f32 v96, v96, v24
    v_mfma_f32_16x16x32_bf16 v[68:71], v[40:43], v[188:191], v[68:71]
    v_exp_f32 v27, v27
    v_mul_f32 v99, v99, v107
    v_mfma_f32_16x16x32_bf16 v[72:75], v[44:47], v[184:187], v[72:75]
    ds_read_b128 v[40:43], v7 offset:24576
    v_fma_f32 v29, v29, v23, v22
    v_mul_f32 v28, v28, v100
    v_mfma_f32_16x16x32_bf16 v[76:79], v[44:47], v[188:191], v[76:79]
    v_fma_f32 v26, v26, v17, v17
    ds_read_b128 v[32:35], v10 offset:384
    ds_read_b128 v[36:39], v10 offset:1408
    s_waitcnt lgkmcnt(5)
    v_mfma_f32_16x16x32_bf16 v[64:67], v[48:51], v[192:195], v[64:67]
    ds_read_b128 v[44:47], v7 offset:25600
    v_rcp_f32 v26, v26
    v_mul_f32 v31, v103, v103
    v_mfma_f32_16x16x32_bf16 v[68:71], v[48:51], v[196:199], v[68:71]
    v_mul_f32 v97, v97, v25
    v_exp_f32 v28, v28
    v_mfma_f32_16x16x32_bf16 v[72:75], v[52:55], v[192:195], v[72:75]
    ds_read_b128 v[48:51], v7 offset:26624
    v_mul_f32 v100, v100, v108
    v_fma_f32 v30, v30, v23, v22
    v_mfma_f32_16x16x32_bf16 v[76:79], v[52:55], v[196:199], v[76:79]
    v_mul_f32 v29, v29, v101
    v_fma_f32 v27, v27, v17, v17
    s_waitcnt lgkmcnt(5)
    v_mfma_f32_16x16x32_bf16 v[64:67], v[56:59], v[200:203], v[64:67]
    ds_read_b128 v[52:55], v7 offset:27648
    v_rcp_f32 v27, v27
    v_mul_f32 v98, v98, v26
    v_mfma_f32_16x16x32_bf16 v[68:71], v[56:59], v[204:207], v[68:71]
    v_exp_f32 v29, v29
    v_mul_f32 v101, v101, v109
    v_mfma_f32_16x16x32_bf16 v[72:75], v[60:63], v[200:203], v[72:75]
    ds_read_b128 v[56:59], v7 offset:28672
    v_fma_f32 v31, v31, v23, v22
    v_mul_f32 v30, v30, v102
    v_mfma_f32_16x16x32_bf16 v[76:79], v[60:63], v[204:207], v[76:79]
    v_fma_f32 v28, v28, v21, v21
    v_rcp_f32 v28, v28
    s_waitcnt lgkmcnt(3)
    v_mfma_f32_16x16x32_bf16 v[64:67], v[40:43], v[208:211], v[64:67]
    ds_read_b128 v[60:63], v7 offset:29696
    v_mul_f32 v99, v99, v27
    v_exp_f32 v30, v30
    v_mfma_f32_16x16x32_bf16 v[68:71], v[40:43], v[212:215], v[68:71]
    v_mul_f32 v102, v102, v110
    v_mul_f32 v31, v31, v103
    v_mfma_f32_16x16x32_bf16 v[72:75], v[44:47], v[208:211], v[72:75]
    ds_read_b128 v[40:43], v7 offset:30720
    v_fma_f32 v29, v29, v21, v21
    v_rcp_f32 v29, v29
    v_mfma_f32_16x16x32_bf16 v[76:79], v[44:47], v[212:215], v[76:79]
    v_mul_f32 v100, v100, v28
    v_exp_f32 v31, v31
    s_waitcnt lgkmcnt(3)
    v_mfma_f32_16x16x32_bf16 v[64:67], v[48:51], v[216:219], v[64:67]
    ds_read_b128 v[44:47], v7 offset:31744
    v_mul_f32 v103, v103, v111
    v_fma_f32 v30, v30, v21, v21
    v_mfma_f32_16x16x32_bf16 v[68:71], v[48:51], v[220:223], v[68:71]
    v_rcp_f32 v30, v30
    v_mul_f32 v101, v101, v29
    v_mfma_f32_16x16x32_bf16 v[72:75], v[52:55], v[216:219], v[72:75]
    ds_read_b128 v[48:51], v7 offset:32768
    v_fma_f32 v31, v31, v21, v21
    v_rcp_f32 v31, v31
    v_mfma_f32_16x16x32_bf16 v[76:79], v[52:55], v[220:223], v[76:79]
    v_mul_f32 v102, v102, v30
    s_nop 0
    s_waitcnt lgkmcnt(3)
    v_mfma_f32_16x16x32_bf16 v[64:67], v[56:59], v[224:227], v[64:67]
    ds_read_b128 v[52:55], v7 offset:33792
    v_mul_f32 v103, v103, v31
    v_cvt_pk_bf16_f32 v24, v96, v97
    v_mfma_f32_16x16x32_bf16 v[68:71], v[56:59], v[228:231], v[68:71]
    v_cvt_pk_bf16_f32 v25, v98, v99
    v_mfma_f32_16x16x32_bf16 v[72:75], v[60:63], v[224:227], v[72:75]
    ds_read_b128 v[56:59], v7 offset:34816
    v_cvt_pk_bf16_f32 v26, v100, v101
    v_mfma_f32_16x16x32_bf16 v[76:79], v[60:63], v[228:231], v[76:79]
    v_cvt_pk_bf16_f32 v27, v102, v103
    s_waitcnt lgkmcnt(3)
    v_mfma_f32_16x16x32_bf16 v[64:67], v[40:43], v[232:235], v[64:67]
    ds_read_b128 v[60:63], v7 offset:35840
    s_add_u32 s43, s42, 327680
    v_mfma_f32_16x16x32_bf16 v[68:71], v[40:43], v[236:239], v[68:71]
    s_nop 0
    v_mfma_f32_16x16x32_bf16 v[72:75], v[44:47], v[232:235], v[72:75]
    s_waitcnt lgkmcnt(0)
    s_waitcnt vmcnt(0)
    s_barrier
    v_mov_b32 v4, 5
    v_mov_b32 v5, 0
    s_mov_b64 exec, 1
    buffer_store_dword v4, v5, s[60:63], s55 offen sc1
    s_mov_b64 exec, -1
    ds_read_b128 v[40:43], v8 offset:0
    v_permlane16_swap_b32 v24, v26
    v_mfma_f32_16x16x32_bf16 v[76:79], v[44:47], v[236:239], v[76:79]
    v_permlane16_swap_b32 v25, v27
    v_mfma_f32_16x16x32_bf16 v[64:67], v[48:51], v[240:243], v[64:67]
    ds_read_b128 v[44:47], v8 offset:1024
    buffer_store_dwordx4 v[24:27], v1, s[16:19], s43 offen sc1
    v_mfma_f32_16x16x32_bf16 v[68:71], v[48:51], v[244:247], v[68:71]
    s_nop 0
    v_mfma_f32_16x16x32_bf16 v[72:75], v[52:55], v[240:243], v[72:75]
    ds_read_b128 v[48:51], v8 offset:2048
    v_mfma_f32_16x16x32_bf16 v[76:79], v[52:55], v[244:247], v[76:79]
    v_mfma_f32_16x16x32_bf16 v[64:67], v[56:59], v[248:251], v[64:67]
    ds_read_b128 v[52:55], v8 offset:3072
    v_mfma_f32_16x16x32_bf16 v[68:71], v[56:59], v[252:255], v[68:71]
    v_mfma_f32_16x16x32_bf16 v[72:75], v[60:63], v[248:251], v[72:75]
    ds_read_b128 v[56:59], v8 offset:4096
    v_mfma_f32_16x16x32_bf16 v[76:79], v[60:63], v[252:255], v[76:79]
    s_waitcnt lgkmcnt(3)
    v_mfma_f32_16x16x32_bf16 v[80:83], v[40:43], v[112:115], 0
    ds_read_b128 v[60:63], v8 offset:5120
    v_mfma_f32_16x16x32_bf16 v[84:87], v[40:43], v[116:119], 0
    v_mfma_f32_16x16x32_bf16 v[88:91], v[44:47], v[112:115], 0
    ds_read_b128 v[40:43], v8 offset:6144
    v_mfma_f32_16x16x32_bf16 v[92:95], v[44:47], v[116:119], 0
    s_waitcnt lgkmcnt(3)
    v_mfma_f32_16x16x32_bf16 v[80:83], v[48:51], v[120:123], v[80:83]
    ds_read_b128 v[44:47], v8 offset:7168
    v_fmac_f32 v64, v32, v16
    v_mfma_f32_16x16x32_bf16 v[84:87], v[48:51], v[124:127], v[84:87]
    v_fmac_f32 v72, v36, v16
    v_fmac_f32 v65, v33, v16
    v_mfma_f32_16x16x32_bf16 v[88:91], v[52:55], v[120:123], v[88:91]
    ds_read_b128 v[48:51], v8 offset:8192
    v_fmac_f32 v73, v37, v16
    v_mul_f32 v24, v64, v64
    v_mfma_f32_16x16x32_bf16 v[92:95], v[52:55], v[124:127], v[92:95]
    v_fmac_f32 v66, v34, v16
    v_fmac_f32 v74, v38, v16
    s_waitcnt lgkmcnt(3)
    v_mfma_f32_16x16x32_bf16 v[80:83], v[56:59], v[128:131], v[80:83]
    ds_read_b128 v[52:55], v8 offset:9216
    v_mul_f32 v25, v65, v65
    v_fma_f32 v24, v24, v19, v18
    v_mfma_f32_16x16x32_bf16 v[84:87], v[56:59], v[132:135], v[84:87]
    v_fmac_f32 v67, v35, v16
    v_fmac_f32 v75, v39, v16
    v_mfma_f32_16x16x32_bf16 v[88:91], v[60:63], v[128:131], v[88:91]
    ds_read_b128 v[56:59], v8 offset:10240
    v_mul_f32 v26, v66, v66
    v_fma_f32 v25, v25, v19, v18
    v_mfma_f32_16x16x32_bf16 v[92:95], v[60:63], v[132:135], v[92:95]
    v_mul_f32 v24, v24, v64
    v_fmac_f32 v68, v32, v20
    s_waitcnt lgkmcnt(3)
    v_mfma_f32_16x16x32_bf16 v[80:83], v[40:43], v[136:139], v[80:83]
    ds_read_b128 v[60:63], v8 offset:11264
    v_fmac_f32 v76, v36, v20
    v_mul_f32 v27, v67, v67
    v_mfma_f32_16x16x32_bf16 v[84:87], v[40:43], v[140:143], v[84:87]
    v_exp_f32 v24, v24
    v_mul_f32 v64, v64, v72
    v_mfma_f32_16x16x32_bf16 v[88:91], v[44:47], v[136:139], v[88:91]
    ds_read_b128 v[40:43], v8 offset:12288
    v_fma_f32 v26, v26, v19, v18
    v_mul_f32 v25, v25, v65
    v_mfma_f32_16x16x32_bf16 v[92:95], v[44:47], v[140:143], v[92:95]
    v_fmac_f32 v69, v33, v20
    v_fmac_f32 v77, v37, v20
    s_waitcnt lgkmcnt(3)
    v_mfma_f32_16x16x32_bf16 v[80:83], v[48:51], v[144:147], v[80:83]
    ds_read_b128 v[44:47], v8 offset:13312
    s_cmp_lg_u32 s28, 0
    s_cbranch_scc1 kc_fl_14
    buffer_load_dword v13, v12, s[60:63], 0 offen sc1
kc_fl_14:
    v_mul_f32 v28, v68, v68
    v_mfma_f32_16x16x32_bf16 v[84:87], v[48:51], v[148:151], v[84:87]
    v_exp_f32 v25, v25
    v_mul_f32 v65, v65, v73
    v_mfma_f32_16x16x32_bf16 v[88:91], v[52:55], v[144:147], v[88:91]
    ds_read_b128 v[48:51], v8 offset:14336
    v_fma_f32 v27, v27, v19, v18
    v_mul_f32 v26, v26, v66
    v_mfma_f32_16x16x32_bf16 v[92:95], v[52:55], v[148:151], v[92:95]
    v_fma_f32 v24, v24, v17, v17
    v_rcp_f32 v24, v24
    s_waitcnt lgkmcnt(3)
    v_mfma_f32_16x16x32_bf16 v[80:83], v[56:59], v[152:155], v[80:83]
    ds_read_b128 v[52:55], v8 offset:15360
    v_fmac_f32 v70, v34, v20
    v_fmac_f32 v78, v38, v20
    v_mfma_f32_16x16x32_bf16 v[84:87], v[56:59], v[156:159], v[84:87]
    v_mul_f32 v29, v69, v69
    v_exp_f32 v26, v26
    v_mfma_f32_16x16x32_bf16 v[88:91], v[60:63], v[152:155], v[88:91]
    ds_read_b128 v[56:59], v8 offset:16384
    v_mul_f32 v66, v66, v74
    v_fma_f32 v28, v28, v23, v22
    v_mfma_f32_16x16x32_bf16 v[92:95], v[60:63], v[156:159], v[92:95]
    v_mul_f32 v27, v27, v67
    v_fma_f32 v25, v25, v17, v17
    s_waitcnt lgkmcnt(3)
    v_mfma_f32_16x16x32_bf16 v[80:83], v[40:43], v[160:163], v[80:83]
    ds_read_b128 v[60:63], v8 offset:17408
    v_rcp_f32 v25, v25
    v_fmac_f32 v71, v35, v20
    v_mfma_f32_16x16x32_bf16 v[84:87], v[40:43], v[164:167], v[84:87]
    v_fmac_f32 v79, v39, v20
    v_mul_f32 v30, v70, v70
    v_mfma_f32_16x16x32_bf16 v[88:91], v[44:47], v[160:163], v[88:91]
    ds_read_b128 v[40:43], v8 offset:18432
    v_mul_f32 v64, v64, v24
    v_exp_f32 v27, v27
    v_mfma_f32_16x16x32_bf16 v[92:95], v[44:47], v[164:167], v[92:95]
    v_mul_f32 v67, v67, v75
    v_fma_f32 v29, v29, v23, v22
    s_waitcnt lgkmcnt(3)
    v_mfma_f32_16x16x32_bf16 v[80:83], v[48:51], v[168:171], v[80:83]
    ds_read_b128 v[44:47], v8 offset:19456
    v_mul_f32 v28, v28, v68
    v_fma_f32 v26, v26, v17, v17
    v_mfma_f32_16x16x32_bf16 v[84:87], v[48:51], v[172:175], v[84:87]
    ds_read_b128 v[32:35], v10 offset:448
    ds_read_b128 v[36:39], v10 offset:1472
    v_rcp_f32 v26, v26
    v_mfma_f32_16x16x32_bf16 v[88:91], v[52:55], v[168:171], v[88:91]
    ds_read_b128 v[48:51], v8 offset:20480
    v_mul_f32 v31, v71, v71
    v_mul_f32 v65, v65, v25
    v_mfma_f32_16x16x32_bf16 v[92:95], v[52:55], v[172:175], v[92:95]
    v_exp_f32 v28, v28
    v_mul_f32 v68, v68, v76
    s_waitcnt lgkmcnt(5)
    v_mfma_f32_16x16x32_bf16 v[80:83], v[56:59], v[176:179], v[80:83]
    ds_read_b128 v[52:55], v8 offset:21504
    v_fma_f32 v30, v30, v23, v22
    v_mul_f32 v29, v29, v69
    v_mfma_f32_16x16x32_bf16 v[84:87], v[56:59], v[180:183], v[84:87]
    v_fma_f32 v27, v27, v17, v17
    v_rcp_f32 v27, v27
    v_mfma_f32_16x16x32_bf16 v[88:91], v[60:63], v[176:179], v[88:91]
    ds_read_b128 v[56:59], v8 offset:22528
    v_mul_f32 v66, v66, v26
    v_exp_f32 v29, v29
    v_mfma_f32_16x16x32_bf16 v[92:95], v[60:63], v[180:183], v[92:95]
    v_mul_f32 v69, v69, v77
    v_fma_f32 v31, v31, v23, v22
    s_waitcnt lgkmcnt(5)
    v_mfma_f32_16x16x32_bf16 v[80:83], v[40:43], v[184:187], v[80:83]
    ds_read_b128 v[60:63], v8 offset:23552
    v_mul_f32 v30, v30, v70
    v_mfma_f32_16x16x32_bf16 v[84:87], v[40:43], v[188:191], v[84:87]
    v_fma_f32 v28, v28, v21, v21
    v_mfma_f32_16x16x32_bf16 v[88:91], v[44:47], v[184:187], v[88:91]
    ds_read_b128 v[40:43], v8 offset:24576
    v_rcp_f32 v28, v28
    v_mfma_f32_16x16x32_bf16 v[92:95], v[44:47], v[188:191], v[92:95]
    v_mul_f32 v67, v67, v27
    s_waitcnt lgkmcnt(3)
    v_mfma_f32_16x16x32_bf16 v[80:83], v[48:51], v[192:195], v[80:83]
    ds_read_b128 v[44:47], v8 offset:25600
    v_exp_f32 v30, v30
    v_mfma_f32_16x16x32_bf16 v[84:87], v[48:51], v[196:199], v[84:87]
    v_mul_f32 v70, v70, v78
    v_mfma_f32_16x16x32_bf16 v[88:91], v[52:55], v[192:195], v[88:91]
    ds_read_b128 v[48:51], v8 offset:26624
    v_mul_f32 v31, v31, v71
    v_mfma_f32_16x16x32_bf16 v[92:95], v[52:55], v[196:199], v[92:95]
    v_fma_f32 v29, v29, v21, v21
    s_waitcnt lgkmcnt(3)
    v_mfma_f32_16x16x32_bf16 v[80:83], v[56:59], v[200:203], v[80:83]
    ds_read_b128 v[52:55], v8 offset:27648
    v_rcp_f32 v29, v29
    v_mfma_f32_16x16x32_bf16 v[84:87], v[56:59], v[204:207], v[84:87]
    v_mul_f32 v68, v68, v28
    v_mfma_f32_16x16x32_bf16 v[88:91], v[60:63], v[200:203], v[88:91]
    ds_read_b128 v[56:59], v8 offset:28672
    v_exp_f32 v31, v31
    v_mfma_f32_16x16x32_bf16 v[92:95], v[60:63], v[204:207], v[92:95]
    v_mul_f32 v71, v71, v79
    s_waitcnt lgkmcnt(3)
    v_mfma_f32_16x16x32_bf16 v[80:83], v[40:43], v[208:211], v[80:83]
    ds_read_b128 v[60:63], v8 offset:29696
    v_fma_f32 v30, v30, v21, v21
    v_mfma_f32_16x16x32_bf16 v[84:87], v[40:43], v[212:215], v[84:87]
    v_rcp_f32 v30, v30
    v_mfma_f32_16x16x32_bf16 v[88:91], v[44:47], v[208:211], v[88:91]
    ds_read_b128 v[40:43], v8 offset:30720
    v_mul_f32 v69, v69, v29
    v_mfma_f32_16x16x32_bf16 v[92:95], v[44:47], v[212:215], v[92:95]
    v_fma_f32 v31, v31, v21, v21
    s_waitcnt lgkmcnt(3)
    v_mfma_f32_16x16x32_bf16 v[80:83], v[48:51], v[216:219], v[80:83]
    ds_read_b128 v[44:47], v8 offset:31744
    v_rcp_f32 v31, v31
    v_mfma_f32_16x16x32_bf16 v[84:87], v[48:51], v[220:223], v[84:87]
    v_mul_f32 v70, v70, v30
    v_mfma_f32_16x16x32_bf16 v[88:91], v[52:55], v[216:219], v[88:91]
    ds_read_b128 v[48:51], v8 offset:32768
    s_nop 0
    v_mfma_f32_16x16x32_bf16 v[92:95], v[52:55], v[220:223], v[92:95]
    v_mul_f32 v71, v71, v31
    s_waitcnt lgkmcnt(3)
    v_mfma_f32_16x16x32_bf16 v[80:83], v[56:59], v[224:227], v[80:83]
    ds_read_b128 v[52:55], v8 offset:33792
    v_cvt_pk_bf16_f32 v24, v64, v65
    v_mfma_f32_16x16x32_bf16 v[84:87], v[56:59], v[228:231], v[84:87]
    v_cvt_pk_bf16_f32 v25, v66, v67
    v_mfma_f32_16x16x32_bf16 v[88:91], v[60:63], v[224:227], v[88:91]
    ds_read_b128 v[56:59], v8 offset:34816
    v_cvt_pk_bf16_f32 v26, v68, v69
    v_mfma_f32_16x16x32_bf16 v[92:95], v[60:63], v[228:231], v[92:95]
    v_cvt_pk_bf16_f32 v27, v70, v71
    s_waitcnt lgkmcnt(3)
    v_mfma_f32_16x16x32_bf16 v[80:83], v[40:43], v[232:235], v[80:83]
    ds_read_b128 v[60:63], v8 offset:35840
    s_add_u32 s43, s42, 393216
    v_mfma_f32_16x16x32_bf16 v[84:87], v[40:43], v[236:239], v[84:87]
    s_nop 0
    v_mfma_f32_16x16x32_bf16 v[88:91], v[44:47], v[232:235], v[88:91]
    s_waitcnt lgkmcnt(0)
    s_waitcnt vmcnt(0)
    s_cmp_lg_u32 s28, 0
    s_cbranch_scc1 kc_fok_15
    s_waitcnt vmcnt(0)
    v_cmp_gt_u32 vcc, 4, v13
    s_nop 1
    s_cbranch_vccnz kc_spin_16
kc_fok_15:
    s_barrier
    v_mov_b32 v4, 6
    v_mov_b32 v5, 0
    s_mov_b64 exec, 1
    buffer_store_dword v4, v5, s[60:63], s55 offen sc1
    s_mov_b64 exec, -1
    ds_read_b128 v[40:43], v3 offset:0
    v_permlane16_swap_b32 v24, v26
    v_mfma_f32_16x16x32_bf16 v[92:95], v[44:47], v[236:239], v[92:95]
    v_permlane16_swap_b32 v25, v27
    v_mfma_f32_16x16x32_bf16 v[80:83], v[48:51], v[240:243], v[80:83]
    ds_read_b128 v[44:47], v3 offset:1024
    buffer_store_dwordx4 v[24:27], v1, s[16:19], s43 offen sc1
    v_mfma_f32_16x16x32_bf16 v[84:87], v[48:51], v[244:247], v[84:87]
    s_nop 0
    v_mfma_f32_16x16x32_bf16 v[88:91], v[52:55], v[240:243], v[88:91]
    ds_read_b128 v[48:51], v3 offset:2048
    v_mfma_f32_16x16x32_bf16 v[92:95], v[52:55], v[244:247], v[92:95]
    v_mfma_f32_16x16x32_bf16 v[80:83], v[56:59], v[248:251], v[80:83]
    ds_read_b128 v[52:55], v3 offset:3072
    v_mfma_f32_16x16x32_bf16 v[84:87], v[56:59], v[252:255], v[84:87]
    v_mfma_f32_16x16x32_bf16 v[88:91], v[60:63], v[248:251], v[88:91]
    ds_read_b128 v[56:59], v3 offset:4096
    v_mfma_f32_16x16x32_bf16 v[92:95], v[60:63], v[252:255], v[92:95]
    s_waitcnt lgkmcnt(3)
    v_mfma_f32_16x16x32_bf16 v[96:99], v[40:43], v[112:115], 0
    ds_read_b128 v[60:63], v3 offset:5120
    v_mfma_f32_16x16x32_bf16 v[100:103], v[40:43], v[116:119], 0
    v_mfma_f32_16x16x32_bf16 v[104:107], v[44:47], v[112:115], 0
    ds_read_b128 v[40:43], v3 offset:6144
    v_mfma_f32_16x16x32_bf16 v[108:111], v[44:47], v[116:119], 0
    s_waitcnt lgkmcnt(3)
    v_mfma_f32_16x16x32_bf16 v[96:99], v[48:51], v[120:123], v[96:99]
    ds_read_b128 v[44:47], v3 offset:7168
    v_fmac_f32 v80, v32, v16
    v_mfma_f32_16x16x32_bf16 v[100:103], v[48:51], v[124:127], v[100:103]
    v_fmac_f32 v88, v36, v16
    v_fmac_f32 v81, v33, v16
    v_mfma_f32_16x16x32_bf16 v[104:107], v[52:55], v[120:123], v[104:107]
    ds_read_b128 v[48:51], v3 offset:8192
    v_fmac_f32 v89, v37, v16
    v_mul_f32 v24, v80, v80
    v_mfma_f32_16x16x32_bf16 v[108:111], v[52:55], v[124:127], v[108:111]
    v_fmac_f32 v82, v34, v16
    v_fmac_f32 v90, v38, v16
    s_waitcnt lgkmcnt(3)
    v_mfma_f32_16x16x32_bf16 v[96:99], v[56:59], v[128:131], v[96:99]
    ds_read_b128 v[52:55], v3 offset:9216
    s_lshl_b32 s24, s53, 7
    s_lshl_b32 s25, s56, 5
    s_add_u32 s24, s24, s25
    v_mfma_f32_16x16x32_bf16 v[100:103], v[56:59], v[132:135], v[100:103]
    v_and_b32 v4, 15, v2
    v_add_u32 v4, s24, v4
    v_lshrrev_b32 v5, 5, v2
    v_mfma_f32_16x16x32_bf16 v[104:107], v[60:63], v[128:131], v[104:107]
    ds_read_b128 v[56:59], v3 offset:10240
    v_mul_u32_u24 v5, 18, v5
    v_bfe_u32 v112, v2, 4, 1
    v_add_u32 v5, v5, v112
    v_mfma_f32_16x16x32_bf16 v[108:111], v[60:63], v[132:135], v[108:111]
    v_lshlrev_b32 v5, 15, v5
    v_lshl_add_u32 v117, v4, 4, v5
    s_mul_i32 s24, s57, 9216
    s_waitcnt lgkmcnt(3)
    v_mfma_f32_16x16x32_bf16 v[96:99], v[40:43], v[136:139], v[96:99]
    ds_read_b128 v[60:63], v3 offset:11264
    v_add_u32 v118, s24, v3
    v_add_u32 v119, s24, v6
    v_add_u32 v120, s24, v7
    v_mfma_f32_16x16x32_bf16 v[100:103], v[40:43], v[140:143], v[100:103]
    v_add_u32 v121, s24, v8
    s_add_u32 s68, s39, s36
    s_add_u32 s69, s39, s31
    v_mfma_f32_16x16x32_bf16 v[104:107], v[44:47], v[136:139], v[104:107]
    ds_read_b128 v[40:43], v3 offset:12288
    v_mul_f32 v25, v81, v81
    v_fma_f32 v24, v24, v19, v18
    v_mfma_f32_16x16x32_bf16 v[108:111], v[44:47], v[140:143], v[108:111]
    s_cmp_ge_u32 s28, 4
    s_cbranch_scc1 kc_skip_17
    s_add_u32 m0, s31, 36864
    s_add_u32 s38, s69, 0
    buffer_load_dwordx4 v3, s[20:23], s38 offen sc1 lds
kc_skip_17:
    v_fmac_f32 v83, v35, v16
    v_fmac_f32 v91, v39, v16
    v_mul_f32 v26, v82, v82
    s_waitcnt lgkmcnt(3)
    v_mfma_f32_16x16x32_bf16 v[96:99], v[48:51], v[144:147], v[96:99]
    ds_read_b128 v[44:47], v3 offset:13312
    s_add_u32 m0, s36, 36864
    v_fma_f32 v25, v25, v19, v18
    v_mul_f32 v24, v24, v80
    v_fmac_f32 v84, v32, v20
    v_mfma_f32_16x16x32_bf16 v[100:103], v[48:51], v[148:151], v[100:103]
    s_add_u32 s38, s68, 0
    v_fmac_f32 v92, v36, v20
    v_mul_f32 v27, v83, v83
    v_exp_f32 v24, v24
    v_mfma_f32_16x16x32_bf16 v[104:107], v[52:55], v[144:147], v[104:107]
    ds_read_b128 v[48:51], v3 offset:14336
    buffer_load_dwordx4 v3, s[20:23], s38 offen offset:0 sc1 lds
    v_mul_f32 v80, v80, v88
    v_fma_f32 v26, v26, v19, v18
    v_mfma_f32_16x16x32_bf16 v[108:111], v[52:55], v[148:151], v[108:111]
    buffer_load_dwordx4 v3, s[20:23], s38 offen offset:1024 sc1 lds
    v_mul_f32 v25, v25, v81
    v_fmac_f32 v85, v33, v20
    s_waitcnt lgkmcnt(3)
    v_mfma_f32_16x16x32_bf16 v[96:99], v[56:59], v[152:155], v[96:99]
    ds_read_b128 v[52:55], v3 offset:15360
    buffer_load_dwordx4 v3, s[20:23], s38 offen offset:2048 sc1 lds
    v_fmac_f32 v93, v37, v20
    v_mul_f32 v28, v84, v84
    v_mfma_f32_16x16x32_bf16 v[100:103], v[56:59], v[156:159], v[100:103]
    buffer_load_dwordx4 v3, s[20:23], s38 offen offset:3072 sc1 lds
    v_exp_f32 v25, v25
    v_mul_f32 v81, v81, v89
    v_mfma_f32_16x16x32_bf16 v[104:107], v[60:63], v[152:155], v[104:107]
    ds_read_b128 v[56:59], v3 offset:16384
    s_cmp_ge_u32 s28, 4
    s_cbranch_scc1 kc_skip_18
    s_add_u32 m0, s31, 73728
    s_add_u32 s38, s69, 36864
    buffer_load_dwordx4 v3, s[20:23], s38 offen sc1 lds
kc_skip_18:
    v_fma_f32 v27, v27, v19, v18
    v_mul_f32 v26, v26, v82
    v_mfma_f32_16x16x32_bf16 v[108:111], v[60:63], v[156:159], v[108:111]
    s_add_u32 m0, s36, 73728
    v_fma_f32 v24, v24, v17, v17
    v_rcp_f32 v24, v24
    s_waitcnt lgkmcnt(3)
    v_mfma_f32_16x16x32_bf16 v[96:99], v[40:43], v[160:163], v[96:99]
    ds_read_b128 v[60:63], v3 offset:17408
    s_add_u32 s38, s68, 36864
    v_fmac_f32 v86, v34, v20
    v_fmac_f32 v94, v38, v20
    v_mfma_f32_16x16x32_bf16 v[100:103], v[40:43], v[164:167], v[100:103]
    buffer_load_dwordx4 v3, s[20:23], s38 offen offset:0 sc1 lds
    v_mul_f32 v29, v85, v85
    v_exp_f32 v26, v26
    v_mfma_f32_16x16x32_bf16 v[104:107], v[44:47], v[160:163], v[104:107]
    ds_read_b128 v[40:43], v3 offset:18432
    buffer_load_dwordx4 v3, s[20:23], s38 offen offset:1024 sc1 lds
    v_mul_f32 v82, v82, v90
    v_fma_f32 v28, v28, v23, v22
    v_mfma_f32_16x16x32_bf16 v[108:111], v[44:47], v[164:167], v[108:111]
    buffer_load_dwordx4 v3, s[20:23], s38 offen offset:2048 sc1 lds
    v_mul_f32 v27, v27, v83
    v_fma_f32 v25, v25, v17, v17
    s_waitcnt lgkmcnt(3)
    v_mfma_f32_16x16x32_bf16 v[96:99], v[48:51], v[168:171], v[96:99]
    ds_read_b128 v[44:47], v3 offset:19456
    buffer_load_dwordx4 v3, s[20:23], s38 offen offset:3072 sc1 lds
    v_rcp_f32 v25, v25
    v_fmac_f32 v87, v35, v20
    v_mfma_f32_16x16x32_bf16 v[100:103], v[48:51], v[172:175], v[100:103]
    v_fmac_f32 v95, v39, v20
    v_mul_f32 v30, v86, v86
    v_mfma_f32_16x16x32_bf16 v[104:107], v[52:55], v[168:171], v[104:107]
    ds_read_b128 v[48:51], v3 offset:20480
    v_mul_f32 v80, v80, v24
    v_exp_f32 v27, v27
    v_mfma_f32_16x16x32_bf16 v[108:111], v[52:55], v[172:175], v[108:111]
    v_mul_f32 v83, v83, v91
    v_fma_f32 v29, v29, v23, v22
    s_waitcnt lgkmcnt(3)
    v_mfma_f32_16x16x32_bf16 v[96:99], v[56:59], v[176:179], v[96:99]
    ds_read_b128 v[52:55], v3 offset:21504
    v_mul_f32 v28, v28, v84
    v_fma_f32 v26, v26, v17, v17
    v_mfma_f32_16x16x32_bf16 v[100:103], v[56:59], v[180:183], v[100:103]
    ds_read_b128 v[32:35], v10 offset:512
    ds_read_b128 v[36:39], v10 offset:1536
    v_rcp_f32 v26, v26
    v_mfma_f32_16x16x32_bf16 v[104:107], v[60:63], v[176:179], v[104:107]
    ds_read_b128 v[56:59], v3 offset:22528
    s_add_u32 s40, s41, 0x0
    v_mul_f32 v31, v87, v87
    v_mul_f32 v81, v81, v25
    v_mfma_f32_16x16x32_bf16 v[108:111], v[60:63], v[180:183], v[108:111]
    buffer_load_dwordx4 v[128:131], v117, s[16:19], s40 offen offset:0 sc1
    v_exp_f32 v28, v28
    v_mul_f32 v84, v84, v92
    s_waitcnt lgkmcnt(5)
    v_mfma_f32_16x16x32_bf16 v[96:99], v[40:43], v[184:187], v[96:99]
    ds_read_b128 v[60:63], v3 offset:23552
    buffer_load_dwordx4 v[132:135], v117, s[16:19], s40 offen offset:256 sc1
    v_fma_f32 v30, v30, v23, v22
    v_mul_f32 v29, v29, v85
    v_mfma_f32_16x16x32_bf16 v[100:103], v[40:43], v[188:191], v[100:103]
    s_add_u32 s70, s41, 0x240000
    v_fma_f32 v27, v27, v17, v17
    v_rcp_f32 v27, v27
    v_mfma_f32_16x16x32_bf16 v[104:107], v[44:47], v[184:187], v[104:107]
    ds_read_b128 v[40:43], v3 offset:24576
    buffer_load_dwordx4 v[136:139], v117, s[16:19], s70 offen offset:0 sc1
    v_mul_f32 v82, v82, v26
    v_exp_f32 v29, v29
    v_mfma_f32_16x16x32_bf16 v[108:111], v[44:47], v[188:191], v[108:111]
    buffer_load_dwordx4 v[140:143], v117, s[16:19], s70 offen offset:256 sc1
    v_mul_f32 v85, v85, v93
    v_fma_f32 v31, v31, v23, v22
    s_waitcnt lgkmcnt(5)
    v_mfma_f32_16x16x32_bf16 v[96:99], v[48:51], v[192:195], v[96:99]
    ds_read_b128 v[44:47], v3 offset:25600
    s_add_u32 s65, s41, 0x10000
    v_mul_f32 v30, v30, v86
    v_fma_f32 v28, v28, v21, v21
    v_mfma_f32_16x16x32_bf16 v[100:103], v[48:51], v[196:199], v[100:103]
    buffer_load_dwordx4 v[144:147], v117, s[16:19], s65 offen offset:0 sc1
    v_rcp_f32 v28, v28
    v_mul_f32 v83, v83, v27
    v_mfma_f32_16x16x32_bf16 v[104:107], v[52:55], v[192:195], v[104:107]
    ds_read_b128 v[48:51], v3 offset:26624
    buffer_load_dwordx4 v[148:151], v117, s[16:19], s65 offen offset:256 sc1
    v_exp_f32 v30, v30
    v_mul_f32 v86, v86, v94
    v_mfma_f32_16x16x32_bf16 v[108:111], v[52:55], v[196:199], v[108:111]
    s_add_u32 s66, s41, 0x250000
    v_mul_f32 v31, v31, v87
    v_fma_f32 v29, v29, v21, v21
    s_waitcnt lgkmcnt(3)
    v_mfma_f32_16x16x32_bf16 v[96:99], v[56:59], v[200:203], v[96:99]
    ds_read_b128 v[52:55], v3 offset:27648
    buffer_load_dwordx4 v[152:155], v117, s[16:19], s66 offen offset:0 sc1
    v_rcp_f32 v29, v29
    v_mfma_f32_16x16x32_bf16 v[100:103], v[56:59], v[204:207], v[100:103]
    buffer_load_dwordx4 v[156:159], v117, s[16:19], s66 offen offset:256 sc1
    v_mul_f32 v84, v84, v28
    v_mfma_f32_16x16x32_bf16 v[104:107], v[60:63], v[200:203], v[104:107]
    ds_read_b128 v[56:59], v3 offset:28672
    s_add_u32 s40, s41, 0x20000
    v_exp_f32 v31, v31
    v_mfma_f32_16x16x32_bf16 v[108:111], v[60:63], v[204:207], v[108:111]
    buffer_load_dwordx4 v[160:163], v117, s[16:19], s40 offen offset:0 sc1
    v_mul_f32 v87, v87, v95
    s_waitcnt lgkmcnt(3)
    v_mfma_f32_16x16x32_bf16 v[96:99], v[40:43], v[208:211], v[96:99]
    ds_read_b128 v[60:63], v3 offset:29696
    buffer_load_dwordx4 v[164:167], v117, s[16:19], s40 offen offset:256 sc1
    v_fma_f32 v30, v30, v21, v21
    v_mfma_f32_16x16x32_bf16 v[100:103], v[40:43], v[212:215], v[100:103]
    s_add_u32 s70, s41, 0x260000
    v_rcp_f32 v30, v30
    v_mfma_f32_16x16x32_bf16 v[104:107], v[44:47], v[208:211], v[104:107]
    ds_read_b128 v[40:43], v3 offset:30720
    buffer_load_dwordx4 v[168:171], v117, s[16:19], s70 offen offset:0 sc1
    v_mul_f32 v85, v85, v29
    v_mfma_f32_16x16x32_bf16 v[108:111], v[44:47], v[212:215], v[108:111]
    buffer_load_dwordx4 v[172:175], v117, s[16:19], s70 offen offset:256 sc1
    v_fma_f32 v31, v31, v21, v21
    s_waitcnt lgkmcnt(3)
    v_mfma_f32_16x16x32_bf16 v[96:99], v[48:51], v[216:219], v[96:99]
    ds_read_b128 v[44:47], v3 offset:31744
    v_rcp_f32 v31, v31
    v_mfma_f32_16x16x32_bf16 v[100:103], v[48:51], v[220:223], v[100:103]
    v_mul_f32 v86, v86, v30
    v_mfma_f32_16x16x32_bf16 v[104:107], v[52:55], v[216:219], v[104:107]
    ds_read_b128 v[48:51], v3 offset:32768
    s_nop 0
    v_mfma_f32_16x16x32_bf16 v[108:111], v[52:55], v[220:223], v[108:111]
    v_mul_f32 v87, v87, v31
    s_waitcnt lgkmcnt(3)
    v_mfma_f32_16x16x32_bf16 v[96:99], v[56:59], v[224:227], v[96:99]
    ds_read_b128 v[52:55], v3 offset:33792
    v_cvt_pk_bf16_f32 v24, v80, v81
    v_mfma_f32_16x16x32_bf16 v[100:103], v[56:59], v[228:231], v[100:103]
    v_cvt_pk_bf16_f32 v25, v82, v83
    v_mfma_f32_16x16x32_bf16 v[104:107], v[60:63], v[224:227], v[104:107]
    ds_read_b128 v[56:59], v3 offset:34816
    v_cvt_pk_bf16_f32 v26, v84, v85
    v_mfma_f32_16x16x32_bf16 v[108:111], v[60:63], v[228:231], v[108:111]
    v_cvt_pk_bf16_f32 v27, v86, v87
    s_waitcnt lgkmcnt(3)
    v_mfma_f32_16x16x32_bf16 v[96:99], v[40:43], v[232:235], v[96:99]
    ds_read_b128 v[60:63], v3 offset:35840
    s_add_u32 s43, s42, 458752
    v_mfma_f32_16x16x32_bf16 v[100:103], v[40:43], v[236:239], v[100:103]
    s_nop 0
    v_mfma_f32_16x16x32_bf16 v[104:107], v[44:47], v[232:235], v[104:107]
    v_permlane16_swap_b32 v24, v26
    v_mfma_f32_16x16x32_bf16 v[108:111], v[44:47], v[236:239], v[108:111]
    v_permlane16_swap_b32 v25, v27
    s_waitcnt lgkmcnt(2)
    v_mfma_f32_16x16x32_bf16 v[96:99], v[48:51], v[240:243], v[96:99]
    buffer_store_dwordx4 v[24:27], v1, s[16:19], s43 offen sc1
    v_mfma_f32_16x16x32_bf16 v[100:103], v[48:51], v[244:247], v[100:103]
    s_nop 0
    v_mfma_f32_16x16x32_bf16 v[104:107], v[52:55], v[240:243], v[104:107]
    v_mfma_f32_16x16x32_bf16 v[108:111], v[52:55], v[244:247], v[108:111]
    s_waitcnt lgkmcnt(0)
    v_mfma_f32_16x16x32_bf16 v[96:99], v[56:59], v[248:251], v[96:99]
    v_mfma_f32_16x16x32_bf16 v[100:103], v[56:59], v[252:255], v[100:103]
    v_mfma_f32_16x16x32_bf16 v[104:107], v[60:63], v[248:251], v[104:107]
    v_mfma_f32_16x16x32_bf16 v[108:111], v[60:63], v[252:255], v[108:111]
    s_cmp_lg_u32 s28, 0
    s_cbranch_scc1 kc_fl_19
    buffer_load_dword v13, v12, s[60:63], 0 offen sc1
kc_fl_19:
    v_fmac_f32 v96, v32, v16
    v_fmac_f32 v104, v36, v16
    v_fmac_f32 v97, v33, v16
    v_fmac_f32 v105, v37, v16
    v_mul_f32 v24, v96, v96
    v_fmac_f32 v98, v34, v16
    v_fmac_f32 v106, v38, v16
    v_mul_f32 v25, v97, v97
    v_fma_f32 v24, v24, v19, v18
    v_fmac_f32 v99, v35, v16
    v_fmac_f32 v107, v39, v16
    v_mul_f32 v26, v98, v98
    v_fma_f32 v25, v25, v19, v18
    v_mul_f32 v24, v24, v96
    v_fmac_f32 v100, v32, v20
    v_fmac_f32 v108, v36, v20
    v_mul_f32 v27, v99, v99
    v_exp_f32 v24, v24
    v_mul_f32 v96, v96, v104
    v_fma_f32 v26, v26, v19, v18
    v_mul_f32 v25, v25, v97
    v_fmac_f32 v101, v33, v20
    v_fmac_f32 v109, v37, v20
    v_mul_f32 v28, v100, v100
    v_exp_f32 v25, v25
    v_mul_f32 v97, v97, v105
    v_fma_f32 v27, v27, v19, v18
    v_mul_f32 v26, v26, v98
    v_fma_f32 v24, v24, v17, v17
    v_rcp_f32 v24, v24
    v_fmac_f32 v102, v34, v20
    v_fmac_f32 v110, v38, v20
    v_mul_f32 v29, v101, v101
    v_exp_f32 v26, v26
    v_mul_f32 v98, v98, v106
    v_fma_f32 v28, v28, v23, v22
    v_mul_f32 v27, v27, v99
    v_fma_f32 v25, v25, v17, v17
    v_rcp_f32 v25, v25
    v_fmac_f32 v103, v35, v20
    v_fmac_f32 v111, v39, v20
    v_mul_f32 v30, v102, v102
    v_mul_f32 v96, v96, v24
    v_exp_f32 v27, v27
    v_mul_f32 v99, v99, v107
    v_fma_f32 v29, v29, v23, v22
    v_mul_f32 v28, v28, v100
    v_fma_f32 v26, v26, v17, v17
    v_rcp_f32 v26, v26
    v_mul_f32 v31, v103, v103
    v_mul_f32 v97, v97, v25
    v_exp_f32 v28, v28
    v_mul_f32 v100, v100, v108
    v_fma_f32 v30, v30, v23, v22
    v_mul_f32 v29, v29, v101
    v_fma_f32 v27, v27, v17, v17
    v_rcp_f32 v27, v27
    v_mul_f32 v98, v98, v26
    v_exp_f32 v29, v29
    v_mul_f32 v101, v101, v109
    v_fma_f32 v31, v31, v23, v22
    v_mul_f32 v30, v30, v102
    v_fma_f32 v28, v28, v21, v21
    v_rcp_f32 v28, v28
    v_mul_f32 v99, v99, v27
    v_exp_f32 v30, v30
    v_mul_f32 v102, v102, v110
    v_mul_f32 v31, v31, v103
    v_fma_f32 v29, v29, v21, v21
    v_rcp_f32 v29, v29
    v_mul_f32 v100, v100, v28
    v_exp_f32 v31, v31
    v_mul_f32 v103, v103, v111
    v_fma_f32 v30, v30, v21, v21
    v_rcp_f32 v30, v30
    v_mul_f32 v101, v101, v29
    v_fma_f32 v31, v31, v21, v21
    v_rcp_f32 v31, v31
    v_mul_f32 v102, v102, v30
    s_nop 0
    v_mul_f32 v103, v103, v31
    v_cvt_pk_bf16_f32 v24, v96, v97
    v_cvt_pk_bf16_f32 v25, v98, v99
    v_cvt_pk_bf16_f32 v26, v100, v101
    v_cvt_pk_bf16_f32 v27, v102, v103
    s_add_u32 s43, s42, 524288
    s_nop 0
    v_permlane16_swap_b32 v24, v26
    v_permlane16_swap_b32 v25, v27
    buffer_store_dwordx4 v[24:27], v1, s[16:19], s43 offen sc1
    s_nop 0
    s_waitcnt vmcnt(18)
    s_barrier
    ds_read_b128 v[44:47], v119 offset:0
    ds_read_b128 v[48:51], v119 offset:1024
    ds_read_b128 v[52:55], v119 offset:2048
    ds_read_b128 v[56:59], v119 offset:3072
    ds_read_b128 v[60:63], v119 offset:4096
    ds_read_b128 v[64:67], v119 offset:5120
    s_waitcnt vmcnt(12)
    s_waitcnt lgkmcnt(4)
    v_mfma_f32_16x16x32_bf16 v[184:187], v[44:47], v[128:131], 0
    ds_read_b128 v[68:71], v119 offset:6144
    v_mfma_f32_16x16x32_bf16 v[220:223], v[44:47], v[132:135], 0
    v_mfma_f32_16x16x32_bf16 v[188:191], v[48:51], v[128:131], 0
    ds_read_b128 v[72:75], v119 offset:7168
    v_mfma_f32_16x16x32_bf16 v[224:227], v[48:51], v[132:135], 0
    s_waitcnt lgkmcnt(4)
    v_mfma_f32_16x16x32_bf16 v[192:195], v[52:55], v[128:131], 0
    ds_read_b128 v[44:47], v119 offset:8192
    v_mfma_f32_16x16x32_bf16 v[228:231], v[52:55], v[132:135], 0
    v_mfma_f32_16x16x32_bf16 v[196:199], v[56:59], v[128:131], 0
    ds_read_b128 v[48:51], v119 offset:18432
    v_mfma_f32_16x16x32_bf16 v[232:235], v[56:59], v[132:135], 0
    s_waitcnt lgkmcnt(4)
    v_mfma_f32_16x16x32_bf16 v[200:203], v[60:63], v[128:131], 0
    ds_read_b128 v[52:55], v119 offset:19456
    v_mfma_f32_16x16x32_bf16 v[236:239], v[60:63], v[132:135], 0
    v_mfma_f32_16x16x32_bf16 v[204:207], v[64:67], v[128:131], 0
    ds_read_b128 v[56:59], v119 offset:20480
    v_mfma_f32_16x16x32_bf16 v[240:243], v[64:67], v[132:135], 0
    s_waitcnt lgkmcnt(4)
    v_mfma_f32_16x16x32_bf16 v[208:211], v[68:71], v[128:131], 0
    ds_read_b128 v[60:63], v119 offset:21504
    v_mfma_f32_16x16x32_bf16 v[244:247], v[68:71], v[132:135], 0
    v_mfma_f32_16x16x32_bf16 v[212:215], v[72:75], v[128:131], 0
    ds_read_b128 v[64:67], v119 offset:22528
    v_mfma_f32_16x16x32_bf16 v[248:251], v[72:75], v[132:135], 0
    s_waitcnt lgkmcnt(4)
    v_mfma_f32_16x16x32_bf16 v[216:219], v[44:47], v[128:131], 0
    ds_read_b128 v[68:71], v119 offset:23552
    v_mfma_f32_16x16x32_bf16 v[252:255], v[44:47], v[132:135], 0
    s_waitcnt vmcnt(10)
    v_mfma_f32_16x16x32_bf16 v[184:187], v[48:51], v[136:139], v[184:187]
    ds_read_b128 v[72:75], v119 offset:24576
    v_mfma_f32_16x16x32_bf16 v[220:223], v[48:51], v[140:143], v[220:223]
    s_waitcnt lgkmcnt(4)
    v_mfma_f32_16x16x32_bf16 v[188:191], v[52:55], v[136:139], v[188:191]
    ds_read_b128 v[44:47], v119 offset:25600
    s_waitcnt vmcnt(0)
    v_mov_b32 v4, 9
    v_mov_b32 v5, 0
    s_mov_b64 exec, 1
    buffer_store_dword v4, v5, s[60:63], s55 offen sc1
    s_mov_b64 exec, -1
    s_add_u32 s65, s41, 0x30000
    v_mfma_f32_16x16x32_bf16 v[224:227], v[52:55], v[140:143], v[224:227]
    buffer_load_dwordx4 v[128:131], v117, s[16:19], s65 offen offset:0 sc1
    v_mfma_f32_16x16x32_bf16 v[192:195], v[56:59], v[136:139], v[192:195]
    ds_read_b128 v[48:51], v119 offset:26624
    buffer_load_dwordx4 v[132:135], v117, s[16:19], s65 offen offset:256 sc1
    v_mfma_f32_16x16x32_bf16 v[228:231], v[56:59], v[140:143], v[228:231]
    s_cmp_ge_u32 s28, 4
    s_cbranch_scc1 kc_skip_20
    s_add_u32 m0, s31, 110592
    s_add_u32 s38, s69, 73728
    buffer_load_dwordx4 v3, s[20:23], s38 offen sc1 lds
kc_skip_20:
    s_waitcnt lgkmcnt(4)
    v_mfma_f32_16x16x32_bf16 v[196:199], v[60:63], v[136:139], v[196:199]
    s_waitcnt lgkmcnt(0)
    s_cmp_lg_u32 s28, 0
    s_cbranch_scc1 kc_fok_21
    s_waitcnt vmcnt(2)
    v_cmp_gt_u32 vcc, 6, v13
    s_nop 1
    s_cbranch_vccnz kc_spin_22
kc_fok_21:
    s_barrier
    ds_read_b128 v[52:55], v120 offset:0
    s_add_u32 m0, s36, 110592
    v_mfma_f32_16x16x32_bf16 v[232:235], v[60:63], v[140:143], v[232:235]
    s_add_u32 s38, s68, 73728
    v_mfma_f32_16x16x32_bf16 v[200:203], v[64:67], v[136:139], v[200:203]
    ds_read_b128 v[56:59], v120 offset:1024
    buffer_load_dwordx4 v3, s[20:23], s38 offen offset:0 sc1 lds
    v_mfma_f32_16x16x32_bf16 v[236:239], v[64:67], v[140:143], v[236:239]
    buffer_load_dwordx4 v3, s[20:23], s38 offen offset:1024 sc1 lds
    v_mfma_f32_16x16x32_bf16 v[204:207], v[68:71], v[136:139], v[204:207]
    ds_read_b128 v[60:63], v120 offset:2048
    buffer_load_dwordx4 v3, s[20:23], s38 offen offset:2048 sc1 lds
    v_mfma_f32_16x16x32_bf16 v[240:243], v[68:71], v[140:143], v[240:243]
    buffer_load_dwordx4 v3, s[20:23], s38 offen offset:3072 sc1 lds
    v_mfma_f32_16x16x32_bf16 v[208:211], v[72:75], v[136:139], v[208:211]
    ds_read_b128 v[64:67], v120 offset:3072
    s_cmp_ge_u32 s28, 4
    s_cbranch_scc1 kc_skip_23
    s_add_u32 m0, s31, 0
    s_add_u32 s38, s69, 110592
    buffer_load_dwordx4 v3, s[20:23], s38 offen sc1 lds
kc_skip_23:
    v_mfma_f32_16x16x32_bf16 v[244:247], v[72:75], v[140:143], v[244:247]
    s_add_u32 m0, s36, 0
    v_mfma_f32_16x16x32_bf16 v[212:215], v[44:47], v[136:139], v[212:215]
    ds_read_b128 v[68:71], v120 offset:4096
    s_add_u32 s38, s68, 110592
    v_mfma_f32_16x16x32_bf16 v[248:251], v[44:47], v[140:143], v[248:251]
    buffer_load_dwordx4 v3, s[20:23], s38 offen offset:0 sc1 lds
    v_mfma_f32_16x16x32_bf16 v[216:219], v[48:51], v[136:139], v[216:219]
    ds_read_b128 v[72:75], v120 offset:5120
    buffer_load_dwordx4 v3, s[20:23], s38 offen offset:1024 sc1 lds
    v_mfma_f32_16x16x32_bf16 v[252:255], v[48:51], v[140:143], v[252:255]
    buffer_load_dwordx4 v3, s[20:23], s38 offen offset:2048 sc1 lds
    s_waitcnt lgkmcnt(4)
    v_mfma_f32_16x16x32_bf16 v[184:187], v[52:55], v[144:147], v[184:187]
    ds_read_b128 v[44:47], v120 offset:6144
    s_add_u32 s66, s41, 0x270000
    v_mfma_f32_16x16x32_bf16 v[220:223], v[52:55], v[148:151], v[220:223]
    buffer_load_dwordx4 v[136:139], v117, s[16:19], s66 offen offset:0 sc1
    v_mfma_f32_16x16x32_bf16 v[188:191], v[56:59], v[144:147], v[188:191]
    ds_read_b128 v[48:51], v120 offset:7168
    buffer_load_dwordx4 v[140:143], v117, s[16:19], s66 offen offset:256 sc1
    v_mfma_f32_16x16x32_bf16 v[224:227], v[56:59], v[148:151], v[224:227]
    buffer_load_dwordx4 v3, s[20:23], s38 offen offset:3072 sc1 lds
    s_waitcnt lgkmcnt(4)
    v_mfma_f32_16x16x32_bf16 v[192:195], v[60:63], v[144:147], v[192:195]
    ds_read_b128 v[52:55], v120 offset:8192
    s_cmp_ge_u32 s28, 4
    s_cbranch_scc1 kc_skip_24
    s_add_u32 m0, s31, 36864
    s_add_u32 s38, s69, 147456
    buffer_load_dwordx4 v3, s[20:23], s38 offen sc1 lds
kc_skip_24:
    v_mfma_f32_16x16x32_bf16 v[228:231], v[60:63], v[148:151], v[228:231]
    s_add_u32 m0, s36, 36864
    v_mfma_f32_16x16x32_bf16 v[196:199], v[64:67], v[144:147], v[196:199]
    ds_read_b128 v[56:59], v120 offset:18432
    s_add_u32 s38, s68, 147456
    v_mfma_f32_16x16x32_bf16 v[232:235], v[64:67], v[148:151], v[232:235]
    buffer_load_dwordx4 v3, s[20:23], s38 offen offset:0 sc1 lds
    s_waitcnt lgkmcnt(4)
    v_mfma_f32_16x16x32_bf16 v[200:203], v[68:71], v[144:147], v[200:203]
    ds_read_b128 v[60:63], v120 offset:19456
    buffer_load_dwordx4 v3, s[20:23], s38 offen offset:1024 sc1 lds
    v_mfma_f32_16x16x32_bf16 v[236:239], v[68:71], v[148:151], v[236:239]
    buffer_load_dwordx4 v3, s[20:23], s38 offen offset:2048 sc1 lds
    v_mfma_f32_16x16x32_bf16 v[204:207], v[72:75], v[144:147], v[204:207]
    ds_read_b128 v[64:67], v120 offset:20480
    buffer_load_dwordx4 v3, s[20:23], s38 offen offset:3072 sc1 lds
    v_mfma_f32_16x16x32_bf16 v[240:243], v[72:75], v[148:151], v[240:243]
    s_waitcnt lgkmcnt(4)
    v_mfma_f32_16x16x32_bf16 v[208:211], v[44:47], v[144:147], v[208:211]
    ds_read_b128 v[68:71], v120 offset:21504
    v_mfma_f32_16x16x32_bf16 v[244:247], v[44:47], v[148:151], v[244:247]
    v_mfma_f32_16x16x32_bf16 v[212:215], v[48:51], v[144:147], v[212:215]
    ds_read_b128 v[72:75], v120 offset:22528
    v_mfma_f32_16x16x32_bf16 v[248:251], v[48:51], v[148:151], v[248:251]
    s_waitcnt lgkmcnt(4)
    v_mfma_f32_16x16x32_bf16 v[216:219], v[52:55], v[144:147], v[216:219]
    ds_read_b128 v[44:47], v120 offset:23552
    v_mfma_f32_16x16x32_bf16 v[252:255], v[52:55], v[148:151], v[252:255]
    v_mfma_f32_16x16x32_bf16 v[184:187], v[56:59], v[152:155], v[184:187]
    ds_read_b128 v[48:51], v120 offset:24576
    s_add_u32 s40, s41, 0x40000
    v_mfma_f32_16x16x32_bf16 v[220:223], v[56:59], v[156:159], v[220:223]
    buffer_load_dwordx4 v[144:147], v117, s[16:19], s40 offen offset:0 sc1
    s_waitcnt lgkmcnt(4)
    v_mfma_f32_16x16x32_bf16 v[188:191], v[60:63], v[152:155], v[188:191]
    ds_read_b128 v[52:55], v120 offset:25600
    buffer_load_dwordx4 v[148:151], v117, s[16:19], s40 offen offset:256 sc1
    v_mfma_f32_16x16x32_bf16 v[224:227], v[60:63], v[156:159], v[224:227]
    v_mfma_f32_16x16x32_bf16 v[192:195], v[64:67], v[152:155], v[192:195]
    ds_read_b128 v[56:59], v120 offset:26624
    v_mfma_f32_16x16x32_bf16 v[228:231], v[64:67], v[156:159], v[228:231]
    s_waitcnt lgkmcnt(4)
    v_mfma_f32_16x16x32_bf16 v[196:199], v[68:71], v[152:155], v[196:199]
    s_waitcnt lgkmcnt(0)
    s_waitcnt vmcnt(12)
    s_barrier
    ds_read_b128 v[60:63], v121 offset:0
    s_cmp_ge_u32 s28, 4
    s_cbranch_scc1 kc_skip_25
    s_add_u32 m0, s31, 73728
    s_add_u32 s38, s69, 184320
    buffer_load_dwordx4 v3, s[20:23], s38 offen sc1 lds
kc_skip_25:
    v_mfma_f32_16x16x32_bf16 v[232:235], v[68:71], v[156:159], v[232:235]
    s_add_u32 m0, s36, 73728
    v_mfma_f32_16x16x32_bf16 v[200:203], v[72:75], v[152:155], v[200:203]
    ds_read_b128 v[64:67], v121 offset:1024
    s_add_u32 s38, s68, 184320
    v_mfma_f32_16x16x32_bf16 v[236:239], v[72:75], v[156:159], v[236:239]
    buffer_load_dwordx4 v3, s[20:23], s38 offen offset:0 sc1 lds
    v_mfma_f32_16x16x32_bf16 v[204:207], v[44:47], v[152:155], v[204:207]
    ds_read_b128 v[68:71], v121 offset:2048
    buffer_load_dwordx4 v3, s[20:23], s38 offen offset:1024 sc1 lds
    v_mfma_f32_16x16x32_bf16 v[240:243], v[44:47], v[156:159], v[240:243]
    buffer_load_dwordx4 v3, s[20:23], s38 offen offset:2048 sc1 lds
    v_mfma_f32_16x16x32_bf16 v[208:211], v[48:51], v[152:155], v[208:211]
    ds_read_b128 v[72:75], v121 offset:3072
    buffer_load_dwordx4 v3, s[20:23], s38 offen offset:3072 sc1 lds
    v_mfma_f32_16x16x32_bf16 v[244:247], v[48:51], v[156:159], v[244:247]
    v_mfma_f32_16x16x32_bf16 v[212:215], v[52:55], v[152:155], v[212:215]
    ds_read_b128 v[44:47], v121 offset:4096
    v_mfma_f32_16x16x32_bf16 v[248:251], v[52:55], v[156:159], v[248:251]
    v_mfma_f32_16x16x32_bf16 v[216:219], v[56:59], v[152:155], v[216:219]
    ds_read_b128 v[48:51], v121 offset:5120
    v_mfma_f32_16x16x32_bf16 v[252:255], v[56:59], v[156:159], v[252:255]
    s_waitcnt lgkmcnt(4)
    v_mfma_f32_16x16x32_bf16 v[184:187], v[60:63], v[160:163], v[184:187]
    ds_read_b128 v[52:55], v121 offset:6144
    s_add_u32 s70, s41, 0x280000
    v_mfma_f32_16x16x32_bf16 v[220:223], v[60:63], v[164:167], v[220:223]
    buffer_load_dwordx4 v[152:155], v117, s[16:19], s70 offen offset:0 sc1
    v_mfma_f32_16x16x32_bf16 v[188:191], v[64:67], v[160:163], v[188:191]
    ds_read_b128 v[56:59], v121 offset:7168
    buffer_load_dwordx4 v[156:159], v117, s[16:19], s70 offen offset:256 sc1
    v_mfma_f32_16x16x32_bf16 v[224:227], v[64:67], v[164:167], v[224:227]
    s_waitcnt lgkmcnt(4)
    v_mfma_f32_16x16x32_bf16 v[192:195], v[68:71], v[160:163], v[192:195]
    ds_read_b128 v[60:63], v121 offset:8192
    v_mfma_f32_16x16x32_bf16 v[228:231], v[68:71], v[164:167], v[228:231]
    v_mfma_f32_16x16x32_bf16 v[196:199], v[72:75], v[160:163], v[196:199]
    ds_read_b128 v[64:67], v121 offset:18432
    v_mfma_f32_16x16x32_bf16 v[232:235], v[72:75], v[164:167], v[232:235]
    s_waitcnt lgkmcnt(4)
    v_mfma_f32_16x16x32_bf16 v[200:203], v[44:47], v[160:163], v[200:203]
    ds_read_b128 v[68:71], v121 offset:19456
    v_mfma_f32_16x16x32_bf16 v[236:239], v[44:47], v[164:167], v[236:239]
    v_mfma_f32_16x16x32_bf16 v[204:207], v[48:51], v[160:163], v[204:207]
    ds_read_b128 v[72:75], v121 offset:20480
    v_mfma_f32_16x16x32_bf16 v[240:243], v[48:51], v[164:167], v[240:243]
    s_waitcnt lgkmcnt(4)
    v_mfma_f32_16x16x32_bf16 v[208:211], v[52:55], v[160:163], v[208:211]
    ds_read_b128 v[44:47], v121 offset:21504
    v_mfma_f32_16x16x32_bf16 v[244:247], v[52:55], v[164:167], v[244:247]
    v_mfma_f32_16x16x32_bf16 v[212:215], v[56:59], v[160:163], v[212:215]
    ds_read_b128 v[48:51], v121 offset:22528
    v_mfma_f32_16x16x32_bf16 v[248:251], v[56:59], v[164:167], v[248:251]
    s_cmp_lg_u32 s28, 0
    s_cbranch_scc1 kc_fl_26
    buffer_load_dword v13, v12, s[60:63], 0 offen sc1
kc_fl_26:
    s_waitcnt lgkmcnt(4)
    v_mfma_f32_16x16x32_bf16 v[216:219], v[60:63], v[160:163], v[216:219]
    ds_read_b128 v[52:55], v121 offset:23552
    v_mfma_f32_16x16x32_bf16 v[252:255], v[60:63], v[164:167], v[252:255]
    v_mfma_f32_16x16x32_bf16 v[184:187], v[64:67], v[168:171], v[184:187]
    ds_read_b128 v[56:59], v121 offset:24576
    v_mfma_f32_16x16x32_bf16 v[220:223], v[64:67], v[172:175], v[220:223]
    s_add_u32 s65, s41, 0x50000
    s_waitcnt lgkmcnt(4)
    v_mfma_f32_16x16x32_bf16 v[188:191], v[68:71], v[168:171], v[188:191]
    ds_read_b128 v[60:63], v121 offset:25600
    v_mfma_f32_16x16x32_bf16 v[224:227], v[68:71], v[172:175], v[224:227]
    buffer_load_dwordx4 v[160:163], v117, s[16:19], s65 offen offset:0 sc1
    v_mfma_f32_16x16x32_bf16 v[192:195], v[72:75], v[168:171], v[192:195]
    ds_read_b128 v[64:67], v121 offset:26624
    v_mfma_f32_16x16x32_bf16 v[228:231], v[72:75], v[172:175], v[228:231]
    buffer_load_dwordx4 v[164:167], v117, s[16:19], s65 offen offset:256 sc1
    s_waitcnt lgkmcnt(4)
    v_mfma_f32_16x16x32_bf16 v[196:199], v[44:47], v[168:171], v[196:199]
    s_waitcnt lgkmcnt(0)
    s_waitcnt vmcnt(14)
    s_barrier
    ds_read_b128 v[68:71], v118 offset:0
    v_mfma_f32_16x16x32_bf16 v[232:235], v[44:47], v[172:175], v[232:235]
    s_cmp_ge_u32 s28, 4
    s_cbranch_scc1 kc_skip_27
    s_add_u32 m0, s31, 110592
    s_add_u32 s38, s69, 221184
    buffer_load_dwordx4 v3, s[20:23], s38 offen sc1 lds
kc_skip_27:
    v_mfma_f32_16x16x32_bf16 v[200:203], v[48:51], v[168:171], v[200:203]
    ds_read_b128 v[72:75], v118 offset:1024
    v_mfma_f32_16x16x32_bf16 v[236:239], v[48:51], v[172:175], v[236:239]
    s_add_u32 m0, s36, 110592
    v_mfma_f32_16x16x32_bf16 v[204:207], v[52:55], v[168:171], v[204:207]
    ds_read_b128 v[44:47], v118 offset:2048
    v_mfma_f32_16x16x32_bf16 v[240:243], v[52:55], v[172:175], v[240:243]
    s_add_u32 s38, s68, 221184
    v_mfma_f32_16x16x32_bf16 v[208:211], v[56:59], v[168:171], v[208:211]
    ds_read_b128 v[48:51], v118 offset:3072
    v_mfma_f32_16x16x32_bf16 v[244:247], v[56:59], v[172:175], v[244:247]
    buffer_load_dwordx4 v3, s[20:23], s38 offen offset:0 sc1 lds
    v_mfma_f32_16x16x32_bf16 v[212:215], v[60:63], v[168:171], v[212:215]
    ds_read_b128 v[52:55], v118 offset:4096
    v_mfma_f32_16x16x32_bf16 v[248:251], v[60:63], v[172:175], v[248:251]
    buffer_load_dwordx4 v3, s[20:23], s38 offen offset:1024 sc1 lds
    v_mfma_f32_16x16x32_bf16 v[216:219], v[64:67], v[168:171], v[216:219]
    ds_read_b128 v[56:59], v118 offset:5120
    v_mfma_f32_16x16x32_bf16 v[252:255], v[64:67], v[172:175], v[252:255]
    buffer_load_dwordx4 v3, s[20:23], s38 offen offset:2048 sc1 lds
    s_waitcnt lgkmcnt(4)
    v_mfma_f32_16x16x32_bf16 v[184:187], v[68:71], v[128:131], v[184:187]
    ds_read_b128 v[60:63], v118 offset:6144
    v_mfma_f32_16x16x32_bf16 v[220:223], v[68:71], v[132:135], v[220:223]
    s_add_u32 s66, s41, 0x290000
    v_mfma_f32_16x16x32_bf16 v[188:191], v[72:75], v[128:131], v[188:191]
    ds_read_b128 v[64:67], v118 offset:7168
    v_mfma_f32_16x16x32_bf16 v[224:227], v[72:75], v[132:135], v[224:227]
    buffer_load_dwordx4 v[168:171], v117, s[16:19], s66 offen offset:0 sc1
    s_waitcnt lgkmcnt(4)
    v_mfma_f32_16x16x32_bf16 v[192:195], v[44:47], v[128:131], v[192:195]
    ds_read_b128 v[68:71], v118 offset:8192
    v_mfma_f32_16x16x32_bf16 v[228:231], v[44:47], v[132:135], v[228:231]
    buffer_load_dwordx4 v[172:175], v117, s[16:19], s66 offen offset:256 sc1
    v_mfma_f32_16x16x32_bf16 v[196:199], v[48:51], v[128:131], v[196:199]
    ds_read_b128 v[72:75], v118 offset:18432
    v_mfma_f32_16x16x32_bf16 v[232:235], v[48:51], v[132:135], v[232:235]
    buffer_load_dwordx4 v3, s[20:23], s38 offen offset:3072 sc1 lds
    s_waitcnt lgkmcnt(4)
    v_mfma_f32_16x16x32_bf16 v[200:203], v[52:55], v[128:131], v[200:203]
    ds_read_b128 v[44:47], v118 offset:19456
    v_mfma_f32_16x16x32_bf16 v[236:239], v[52:55], v[132:135], v[236:239]
    v_mfma_f32_16x16x32_bf16 v[204:207], v[56:59], v[128:131], v[204:207]
    ds_read_b128 v[48:51], v118 offset:20480
    v_mfma_f32_16x16x32_bf16 v[240:243], v[56:59], v[132:135], v[240:243]
    s_waitcnt lgkmcnt(4)
    v_mfma_f32_16x16x32_bf16 v[208:211], v[60:63], v[128:131], v[208:211]
    ds_read_b128 v[52:55], v118 offset:21504
    v_mfma_f32_16x16x32_bf16 v[244:247], v[60:63], v[132:135], v[244:247]
    v_mfma_f32_16x16x32_bf16 v[212:215], v[64:67], v[128:131], v[212:215]
    ds_read_b128 v[56:59], v118 offset:22528
    v_mfma_f32_16x16x32_bf16 v[248:251], v[64:67], v[132:135], v[248:251]
    s_waitcnt lgkmcnt(4)
    v_mfma_f32_16x16x32_bf16 v[216:219], v[68:71], v[128:131], v[216:219]
    ds_read_b128 v[60:63], v118 offset:23552
    v_mfma_f32_16x16x32_bf16 v[252:255], v[68:71], v[132:135], v[252:255]
    v_mfma_f32_16x16x32_bf16 v[184:187], v[72:75], v[136:139], v[184:187]
    ds_read_b128 v[64:67], v118 offset:24576
    v_mfma_f32_16x16x32_bf16 v[220:223], v[72:75], v[140:143], v[220:223]
    s_waitcnt lgkmcnt(4)
    v_mfma_f32_16x16x32_bf16 v[188:191], v[44:47], v[136:139], v[188:191]
    ds_read_b128 v[68:71], v118 offset:25600
    v_mfma_f32_16x16x32_bf16 v[224:227], v[44:47], v[140:143], v[224:227]
    v_mfma_f32_16x16x32_bf16 v[192:195], v[48:51], v[136:139], v[192:195]
    ds_read_b128 v[72:75], v118 offset:26624
    v_mfma_f32_16x16x32_bf16 v[228:231], v[48:51], v[140:143], v[228:231]
    s_waitcnt lgkmcnt(4)
    v_mfma_f32_16x16x32_bf16 v[196:199], v[52:55], v[136:139], v[196:199]
    s_waitcnt lgkmcnt(0)
    s_waitcnt vmcnt(16)
    s_cmp_lg_u32 s28, 0
    s_cbranch_scc1 kc_fok_28
    s_waitcnt vmcnt(8)
    v_cmp_gt_u32 vcc, 9, v13
    s_nop 1
    s_cbranch_vccnz kc_spin_29
kc_fok_28:
    s_barrier
    ds_read_b128 v[44:47], v119 offset:0
    v_mfma_f32_16x16x32_bf16 v[232:235], v[52:55], v[140:143], v[232:235]
    s_add_u32 s40, s41, 0x60000
    v_mfma_f32_16x16x32_bf16 v[200:203], v[56:59], v[136:139], v[200:203]
    ds_read_b128 v[48:51], v119 offset:1024
    v_mfma_f32_16x16x32_bf16 v[236:239], v[56:59], v[140:143], v[236:239]
    buffer_load_dwordx4 v[128:131], v117, s[16:19], s40 offen offset:0 sc1
    v_mfma_f32_16x16x32_bf16 v[204:207], v[60:63], v[136:139], v[204:207]
    ds_read_b128 v[52:55], v119 offset:2048
    v_mfma_f32_16x16x32_bf16 v[240:243], v[60:63], v[140:143], v[240:243]
    buffer_load_dwordx4 v[132:135], v117, s[16:19], s40 offen offset:256 sc1
    v_mfma_f32_16x16x32_bf16 v[208:211], v[64:67], v[136:139], v[208:211]
    ds_read_b128 v[56:59], v119 offset:3072
    v_mfma_f32_16x16x32_bf16 v[244:247], v[64:67], v[140:143], v[244:247]
    s_cmp_ge_u32 s28, 4
    s_cbranch_scc1 kc_skip_30
    s_add_u32 m0, s31, 0
    s_add_u32 s38, s69, 258048
    buffer_load_dwordx4 v3, s[20:23], s38 offen sc1 lds
kc_skip_30:
    v_mfma_f32_16x16x32_bf16 v[212:215], v[68:71], v[136:139], v[212:215]
    ds_read_b128 v[60:63], v119 offset:4096
    v_mfma_f32_16x16x32_bf16 v[248:251], v[68:71], v[140:143], v[248:251]
    s_add_u32 m0, s36, 0
    v_mfma_f32_16x16x32_bf16 v[216:219], v[72:75], v[136:139], v[216:219]
    ds_read_b128 v[64:67], v119 offset:5120
    v_mfma_f32_16x16x32_bf16 v[252:255], v[72:75], v[140:143], v[252:255]
    s_add_u32 s38, s68, 258048
    s_waitcnt vmcnt(16)
    s_waitcnt lgkmcnt(4)
    v_mfma_f32_16x16x32_bf16 v[184:187], v[44:47], v[144:147], v[184:187]
    ds_read_b128 v[68:71], v119 offset:6144
    v_mfma_f32_16x16x32_bf16 v[220:223], v[44:47], v[148:151], v[220:223]
    s_add_u32 s70, s41, 0x2a0000
    v_mfma_f32_16x16x32_bf16 v[188:191], v[48:51], v[144:147], v[188:191]
    ds_read_b128 v[72:75], v119 offset:7168
    v_mfma_f32_16x16x32_bf16 v[224:227], v[48:51], v[148:151], v[224:227]
    buffer_load_dwordx4 v[136:139], v117, s[16:19], s70 offen offset:0 sc1
    s_waitcnt lgkmcnt(4)
    v_mfma_f32_16x16x32_bf16 v[192:195], v[52:55], v[144:147], v[192:195]
    ds_read_b128 v[44:47], v119 offset:8192
    v_mfma_f32_16x16x32_bf16 v[228:231], v[52:55], v[148:151], v[228:231]
    buffer_load_dwordx4 v[140:143], v117, s[16:19], s70 offen offset:256 sc1
    v_mfma_f32_16x16x32_bf16 v[196:199], v[56:59], v[144:147], v[196:199]
    ds_read_b128 v[48:51], v119 offset:18432
    v_mfma_f32_16x16x32_bf16 v[232:235], v[56:59], v[148:151], v[232:235]
    buffer_load_dwordx4 v3, s[20:23], s38 offen offset:0 sc1 lds
    s_waitcnt lgkmcnt(4)
    v_mfma_f32_16x16x32_bf16 v[200:203], v[60:63], v[144:147], v[200:203]
    ds_read_b128 v[52:55], v119 offset:19456
    v_mfma_f32_16x16x32_bf16 v[236:239], v[60:63], v[148:151], v[236:239]
    buffer_load_dwordx4 v3, s[20:23], s38 offen offset:1024 sc1 lds
    v_mfma_f32_16x16x32_bf16 v[204:207], v[64:67], v[144:147], v[204:207]
    ds_read_b128 v[56:59], v119 offset:20480
    v_mfma_f32_16x16x32_bf16 v[240:243], v[64:67], v[148:151], v[240:243]
    buffer_load_dwordx4 v3, s[20:23], s38 offen offset:2048 sc1 lds
    s_waitcnt lgkmcnt(4)
    v_mfma_f32_16x16x32_bf16 v[208:211], v[68:71], v[144:147], v[208:211]
    ds_read_b128 v[60:63], v119 offset:21504
    v_mfma_f32_16x16x32_bf16 v[244:247], v[68:71], v[148:151], v[244:247]
    buffer_load_dwordx4 v3, s[20:23], s38 offen offset:3072 sc1 lds
    v_mfma_f32_16x16x32_bf16 v[212:215], v[72:75], v[144:147], v[212:215]
    ds_read_b128 v[64:67], v119 offset:22528
    v_mfma_f32_16x16x32_bf16 v[248:251], v[72:75], v[148:151], v[248:251]
    s_waitcnt lgkmcnt(4)
    v_mfma_f32_16x16x32_bf16 v[216:219], v[44:47], v[144:147], v[216:219]
    ds_read_b128 v[68:71], v119 offset:23552
    v_mfma_f32_16x16x32_bf16 v[252:255], v[44:47], v[148:151], v[252:255]
    s_waitcnt vmcnt(16)
    v_mfma_f32_16x16x32_bf16 v[184:187], v[48:51], v[152:155], v[184:187]
    ds_read_b128 v[72:75], v119 offset:24576
    v_mfma_f32_16x16x32_bf16 v[220:223], v[48:51], v[156:159], v[220:223]
    s_add_u32 s65, s41, 0x70000
    s_waitcnt lgkmcnt(4)
    v_mfma_f32_16x16x32_bf16 v[188:191], v[52:55], v[152:155], v[188:191]
    ds_read_b128 v[44:47], v119 offset:25600
    v_mfma_f32_16x16x32_bf16 v[224:227], v[52:55], v[156:159], v[224:227]
    buffer_load_dwordx4 v[144:147], v117, s[16:19], s65 offen offset:0 sc1
    v_mfma_f32_16x16x32_bf16 v[192:195], v[56:59], v[152:155], v[192:195]
    ds_read_b128 v[48:51], v119 offset:26624
    v_mfma_f32_16x16x32_bf16 v[228:231], v[56:59], v[156:159], v[228:231]
    buffer_load_dwordx4 v[148:151], v117, s[16:19], s65 offen offset:256 sc1
    s_waitcnt lgkmcnt(4)
    v_mfma_f32_16x16x32_bf16 v[196:199], v[60:63], v[152:155], v[196:199]
    s_waitcnt lgkmcnt(0)
    s_barrier
    ds_read_b128 v[52:55], v120 offset:0
    v_mfma_f32_16x16x32_bf16 v[232:235], v[60:63], v[156:159], v[232:235]
    s_cmp_ge_u32 s28, 4
    s_cbranch_scc1 kc_skip_31
    s_add_u32 m0, s31, 36864
    s_add_u32 s38, s69, 294912
    buffer_load_dwordx4 v3, s[20:23], s38 offen sc1 lds
kc_skip_31:
    v_mfma_f32_16x16x32_bf16 v[200:203], v[64:67], v[152:155], v[200:203]
    ds_read_b128 v[56:59], v120 offset:1024
    v_mfma_f32_16x16x32_bf16 v[236:239], v[64:67], v[156:159], v[236:239]
    s_add_u32 m0, s36, 36864
    v_mfma_f32_16x16x32_bf16 v[204:207], v[68:71], v[152:155], v[204:207]
    ds_read_b128 v[60:63], v120 offset:2048
    v_mfma_f32_16x16x32_bf16 v[240:243], v[68:71], v[156:159], v[240:243]
    s_add_u32 s38, s68, 294912
    v_mfma_f32_16x16x32_bf16 v[208:211], v[72:75], v[152:155], v[208:211]
    ds_read_b128 v[64:67], v120 offset:3072
    v_mfma_f32_16x16x32_bf16 v[244:247], v[72:75], v[156:159], v[244:247]
    buffer_load_dwordx4 v3, s[20:23], s38 offen offset:0 sc1 lds
    v_mfma_f32_16x16x32_bf16 v[212:215], v[44:47], v[152:155], v[212:215]
    ds_read_b128 v[68:71], v120 offset:4096
    v_mfma_f32_16x16x32_bf16 v[248:251], v[44:47], v[156:159], v[248:251]
    buffer_load_dwordx4 v3, s[20:23], s38 offen offset:1024 sc1 lds
    v_mfma_f32_16x16x32_bf16 v[216:219], v[48:51], v[152:155], v[216:219]
    ds_read_b128 v[72:75], v120 offset:5120
    v_mfma_f32_16x16x32_bf16 v[252:255], v[48:51], v[156:159], v[252:255]
    buffer_load_dwordx4 v3, s[20:23], s38 offen offset:2048 sc1 lds
    s_waitcnt vmcnt(19)
    s_waitcnt lgkmcnt(4)
    v_mfma_f32_16x16x32_bf16 v[184:187], v[52:55], v[160:163], v[184:187]
    ds_read_b128 v[44:47], v120 offset:6144
    v_mfma_f32_16x16x32_bf16 v[220:223], v[52:55], v[164:167], v[220:223]
    s_add_u32 s66, s41, 0x2b0000
    v_mfma_f32_16x16x32_bf16 v[188:191], v[56:59], v[160:163], v[188:191]
    ds_read_b128 v[48:51], v120 offset:7168
    v_mfma_f32_16x16x32_bf16 v[224:227], v[56:59], v[164:167], v[224:227]
    buffer_load_dwordx4 v[152:155], v117, s[16:19], s66 offen offset:0 sc1
    s_waitcnt lgkmcnt(4)
    v_mfma_f32_16x16x32_bf16 v[192:195], v[60:63], v[160:163], v[192:195]
    ds_read_b128 v[52:55], v120 offset:8192
    v_mfma_f32_16x16x32_bf16 v[228:231], v[60:63], v[164:167], v[228:231]
    buffer_load_dwordx4 v[156:159], v117, s[16:19], s66 offen offset:256 sc1
    v_mfma_f32_16x16x32_bf16 v[196:199], v[64:67], v[160:163], v[196:199]
    ds_read_b128 v[56:59], v120 offset:18432
    v_mfma_f32_16x16x32_bf16 v[232:235], v[64:67], v[164:167], v[232:235]
    buffer_load_dwordx4 v3, s[20:23], s38 offen offset:3072 sc1 lds
    s_waitcnt lgkmcnt(4)
    v_mfma_f32_16x16x32_bf16 v[200:203], v[68:71], v[160:163], v[200:203]
    ds_read_b128 v[60:63], v120 offset:19456
    v_mfma_f32_16x16x32_bf16 v[236:239], v[68:71], v[164:167], v[236:239]
    v_mfma_f32_16x16x32_bf16 v[204:207], v[72:75], v[160:163], v[204:207]
    ds_read_b128 v[64:67], v120 offset:20480
    v_mfma_f32_16x16x32_bf16 v[240:243], v[72:75], v[164:167], v[240:243]
    s_waitcnt lgkmcnt(4)
    v_mfma_f32_16x16x32_bf16 v[208:211], v[44:47], v[160:163], v[208:211]
    ds_read_b128 v[68:71], v120 offset:21504
    v_mfma_f32_16x16x32_bf16 v[244:247], v[44:47], v[164:167], v[244:247]
    v_mfma_f32_16x16x32_bf16 v[212:215], v[48:51], v[160:163], v[212:215]
    ds_read_b128 v[72:75], v120 offset:22528
    v_mfma_f32_16x16x32_bf16 v[248:251], v[48:51], v[164:167], v[248:251]
    s_waitcnt lgkmcnt(4)
    v_mfma_f32_16x16x32_bf16 v[216:219], v[52:55], v[160:163], v[216:219]
    ds_read_b128 v[44:47], v120 offset:23552
    v_mfma_f32_16x16x32_bf16 v[252:255], v[52:55], v[164:167], v[252:255]
    s_waitcnt vmcnt(17)
    v_mfma_f32_16x16x32_bf16 v[184:187], v[56:59], v[168:171], v[184:187]
    ds_read_b128 v[48:51], v120 offset:24576
    v_mfma_f32_16x16x32_bf16 v[220:223], v[56:59], v[172:175], v[220:223]
    s_add_u32 s40, s41, 0x80000
    s_waitcnt lgkmcnt(4)
    v_mfma_f32_16x16x32_bf16 v[188:191], v[60:63], v[168:171], v[188:191]
    ds_read_b128 v[52:55], v120 offset:25600
    v_mfma_f32_16x16x32_bf16 v[224:227], v[60:63], v[172:175], v[224:227]
    buffer_load_dwordx4 v[160:163], v117, s[16:19], s40 offen offset:0 sc1
    v_mfma_f32_16x16x32_bf16 v[192:195], v[64:67], v[168:171], v[192:195]
    ds_read_b128 v[56:59], v120 offset:26624
    v_mfma_f32_16x16x32_bf16 v[228:231], v[64:67], v[172:175], v[228:231]
    buffer_load_dwordx4 v[164:167], v117, s[16:19], s40 offen offset:256 sc1
    s_waitcnt lgkmcnt(4)
    v_mfma_f32_16x16x32_bf16 v[196:199], v[68:71], v[168:171], v[196:199]
    s_waitcnt lgkmcnt(0)
    s_waitcnt vmcnt(18)
    s_barrier
    ds_read_b128 v[60:63], v121 offset:0
    v_mfma_f32_16x16x32_bf16 v[232:235], v[68:71], v[172:175], v[232:235]
    v_mfma_f32_16x16x32_bf16 v[200:203], v[72:75], v[168:171], v[200:203]
    ds_read_b128 v[64:67], v121 offset:1024
    v_mfma_f32_16x16x32_bf16 v[236:239], v[72:75], v[172:175], v[236:239]
    v_mfma_f32_16x16x32_bf16 v[204:207], v[44:47], v[168:171], v[204:207]
    ds_read_b128 v[68:71], v121 offset:2048
    v_mfma_f32_16x16x32_bf16 v[240:243], v[44:47], v[172:175], v[240:243]
    v_mfma_f32_16x16x32_bf16 v[208:211], v[48:51], v[168:171], v[208:211]
    ds_read_b128 v[72:75], v121 offset:3072
    v_mfma_f32_16x16x32_bf16 v[244:247], v[48:51], v[172:175], v[244:247]
    v_mfma_f32_16x16x32_bf16 v[212:215], v[52:55], v[168:171], v[212:215]
    ds_read_b128 v[44:47], v121 offset:4096
    v_mfma_f32_16x16x32_bf16 v[248:251], v[52:55], v[172:175], v[248:251]
    v_mfma_f32_16x16x32_bf16 v[216:219], v[56:59], v[168:171], v[216:219]
    ds_read_b128 v[48:51], v121 offset:5120
    v_mfma_f32_16x16x32_bf16 v[252:255], v[56:59], v[172:175], v[252:255]
    s_waitcnt vmcnt(16)
    s_waitcnt lgkmcnt(4)
    v_mfma_f32_16x16x32_bf16 v[184:187], v[60:63], v[128:131], v[184:187]
    ds_read_b128 v[52:55], v121 offset:6144
    v_mfma_f32_16x16x32_bf16 v[220:223], v[60:63], v[132:135], v[220:223]
    s_add_u32 s70, s41, 0x2c0000
    v_mfma_f32_16x16x32_bf16 v[188:191], v[64:67], v[128:131], v[188:191]
    ds_read_b128 v[56:59], v121 offset:7168
    v_mfma_f32_16x16x32_bf16 v[224:227], v[64:67], v[132:135], v[224:227]
    buffer_load_dwordx4 v[168:171], v117, s[16:19], s70 offen offset:0 sc1
    s_waitcnt lgkmcnt(4)
    v_mfma_f32_16x16x32_bf16 v[192:195], v[68:71], v[128:131], v[192:195]
    ds_read_b128 v[60:63], v121 offset:8192
    v_mfma_f32_16x16x32_bf16 v[228:231], v[68:71], v[132:135], v[228:231]
    buffer_load_dwordx4 v[172:175], v117, s[16:19], s70 offen offset:256 sc1
    v_mfma_f32_16x16x32_bf16 v[196:199], v[72:75], v[128:131], v[196:199]
    ds_read_b128 v[64:67], v121 offset:18432
    v_mfma_f32_16x16x32_bf16 v[232:235], v[72:75], v[132:135], v[232:235]
    s_waitcnt lgkmcnt(4)
    v_mfma_f32_16x16x32_bf16 v[200:203], v[44:47], v[128:131], v[200:203]
    ds_read_b128 v[68:71], v121 offset:19456
    v_mfma_f32_16x16x32_bf16 v[236:239], v[44:47], v[132:135], v[236:239]
    v_mfma_f32_16x16x32_bf16 v[204:207], v[48:51], v[128:131], v[204:207]
    ds_read_b128 v[72:75], v121 offset:20480
    v_mfma_f32_16x16x32_bf16 v[240:243], v[48:51], v[132:135], v[240:243]
    s_waitcnt lgkmcnt(4)
    v_mfma_f32_16x16x32_bf16 v[208:211], v[52:55], v[128:131], v[208:211]
    ds_read_b128 v[44:47], v121 offset:21504
    v_mfma_f32_16x16x32_bf16 v[244:247], v[52:55], v[132:135], v[244:247]
    v_mfma_f32_16x16x32_bf16 v[212:215], v[56:59], v[128:131], v[212:215]
    ds_read_b128 v[48:51], v121 offset:22528
    v_mfma_f32_16x16x32_bf16 v[248:251], v[56:59], v[132:135], v[248:251]
    s_waitcnt lgkmcnt(4)
    v_mfma_f32_16x16x32_bf16 v[216:219], v[60:63], v[128:131], v[216:219]
    ds_read_b128 v[52:55], v121 offset:23552
    v_mfma_f32_16x16x32_bf16 v[252:255], v[60:63], v[132:135], v[252:255]
    s_waitcnt vmcnt(16)
    v_mfma_f32_16x16x32_bf16 v[184:187], v[64:67], v[136:139], v[184:187]
    ds_read_b128 v[56:59], v121 offset:24576
    v_mfma_f32_16x16x32_bf16 v[220:223], v[64:67], v[140:143], v[220:223]
    s_waitcnt lgkmcnt(4)
    v_mfma_f32_16x16x32_bf16 v[188:191], v[68:71], v[136:139], v[188:191]
    ds_read_b128 v[60:63], v121 offset:25600
    v_mfma_f32_16x16x32_bf16 v[224:227], v[68:71], v[140:143], v[224:227]
    v_mfma_f32_16x16x32_bf16 v[192:195], v[72:75], v[136:139], v[192:195]
    ds_read_b128 v[64:67], v121 offset:26624
    v_mfma_f32_16x16x32_bf16 v[228:231], v[72:75], v[140:143], v[228:231]
    s_waitcnt lgkmcnt(4)
    v_mfma_f32_16x16x32_bf16 v[196:199], v[44:47], v[136:139], v[196:199]
    s_waitcnt lgkmcnt(0)
    s_waitcnt vmcnt(12)
    s_barrier
    ds_read_b128 v[68:71], v118 offset:0
    v_mfma_f32_16x16x32_bf16 v[232:235], v[44:47], v[140:143], v[232:235]
    v_mfma_f32_16x16x32_bf16 v[200:203], v[48:51], v[136:139], v[200:203]
    ds_read_b128 v[72:75], v118 offset:1024
    v_mfma_f32_16x16x32_bf16 v[236:239], v[48:51], v[140:143], v[236:239]
    v_mfma_f32_16x16x32_bf16 v[204:207], v[52:55], v[136:139], v[204:207]
    ds_read_b128 v[44:47], v118 offset:2048
    v_mfma_f32_16x16x32_bf16 v[240:243], v[52:55], v[140:143], v[240:243]
    v_mfma_f32_16x16x32_bf16 v[208:211], v[56:59], v[136:139], v[208:211]
    ds_read_b128 v[48:51], v118 offset:3072
    v_mfma_f32_16x16x32_bf16 v[244:247], v[56:59], v[140:143], v[244:247]
    v_mfma_f32_16x16x32_bf16 v[212:215], v[60:63], v[136:139], v[212:215]
    ds_read_b128 v[52:55], v118 offset:4096
    v_mfma_f32_16x16x32_bf16 v[248:251], v[60:63], v[140:143], v[248:251]
    v_mfma_f32_16x16x32_bf16 v[216:219], v[64:67], v[136:139], v[216:219]
    ds_read_b128 v[56:59], v118 offset:5120
    v_mfma_f32_16x16x32_bf16 v[252:255], v[64:67], v[140:143], v[252:255]
    s_waitcnt vmcnt(10)
    s_waitcnt lgkmcnt(4)
    v_mfma_f32_16x16x32_bf16 v[184:187], v[68:71], v[144:147], v[184:187]
    ds_read_b128 v[60:63], v118 offset:6144
    v_mfma_f32_16x16x32_bf16 v[220:223], v[68:71], v[148:151], v[220:223]
    v_mfma_f32_16x16x32_bf16 v[188:191], v[72:75], v[144:147], v[188:191]
    ds_read_b128 v[64:67], v118 offset:7168
    v_mfma_f32_16x16x32_bf16 v[224:227], v[72:75], v[148:151], v[224:227]
    s_waitcnt lgkmcnt(4)
    v_mfma_f32_16x16x32_bf16 v[192:195], v[44:47], v[144:147], v[192:195]
    ds_read_b128 v[68:71], v118 offset:8192
    v_mfma_f32_16x16x32_bf16 v[228:231], v[44:47], v[148:151], v[228:231]
    v_mfma_f32_16x16x32_bf16 v[196:199], v[48:51], v[144:147], v[196:199]
    ds_read_b128 v[72:75], v118 offset:18432
    v_mfma_f32_16x16x32_bf16 v[232:235], v[48:51], v[148:151], v[232:235]
    s_waitcnt lgkmcnt(4)
    v_mfma_f32_16x16x32_bf16 v[200:203], v[52:55], v[144:147], v[200:203]
    ds_read_b128 v[44:47], v118 offset:19456
    v_mfma_f32_16x16x32_bf16 v[236:239], v[52:55], v[148:151], v[236:239]
    v_mfma_f32_16x16x32_bf16 v[204:207], v[56:59], v[144:147], v[204:207]
    ds_read_b128 v[48:51], v118 offset:20480
    v_mfma_f32_16x16x32_bf16 v[240:243], v[56:59], v[148:151], v[240:243]
    s_waitcnt lgkmcnt(4)
    v_mfma_f32_16x16x32_bf16 v[208:211], v[60:63], v[144:147], v[208:211]
    ds_read_b128 v[52:55], v118 offset:21504
    v_mfma_f32_16x16x32_bf16 v[244:247], v[60:63], v[148:151], v[244:247]
    v_mfma_f32_16x16x32_bf16 v[212:215], v[64:67], v[144:147], v[212:215]
    ds_read_b128 v[56:59], v118 offset:22528
    v_mfma_f32_16x16x32_bf16 v[248:251], v[64:67], v[148:151], v[248:251]
    s_waitcnt lgkmcnt(4)
    v_mfma_f32_16x16x32_bf16 v[216:219], v[68:71], v[144:147], v[216:219]
    ds_read_b128 v[60:63], v118 offset:23552
    v_mfma_f32_16x16x32_bf16 v[252:255], v[68:71], v[148:151], v[252:255]
    s_waitcnt vmcnt(5)
    v_mfma_f32_16x16x32_bf16 v[184:187], v[72:75], v[152:155], v[184:187]
    ds_read_b128 v[64:67], v118 offset:24576
    v_mfma_f32_16x16x32_bf16 v[220:223], v[72:75], v[156:159], v[220:223]
    s_waitcnt lgkmcnt(4)
    v_mfma_f32_16x16x32_bf16 v[188:191], v[44:47], v[152:155], v[188:191]
    ds_read_b128 v[68:71], v118 offset:25600
    v_mfma_f32_16x16x32_bf16 v[224:227], v[44:47], v[156:159], v[224:227]
    v_mfma_f32_16x16x32_bf16 v[192:195], v[48:51], v[152:155], v[192:195]
    ds_read_b128 v[72:75], v118 offset:26624
    v_mfma_f32_16x16x32_bf16 v[228:231], v[48:51], v[156:159], v[228:231]
    s_waitcnt lgkmcnt(4)
    v_mfma_f32_16x16x32_bf16 v[196:199], v[52:55], v[152:155], v[196:199]
    s_waitcnt lgkmcnt(0)
    s_waitcnt vmcnt(4)
    s_barrier
    ds_read_b128 v[44:47], v119 offset:0
    v_mfma_f32_16x16x32_bf16 v[232:235], v[52:55], v[156:159], v[232:235]
    v_mfma_f32_16x16x32_bf16 v[200:203], v[56:59], v[152:155], v[200:203]
    ds_read_b128 v[48:51], v119 offset:1024
    v_mfma_f32_16x16x32_bf16 v[236:239], v[56:59], v[156:159], v[236:239]
    v_mfma_f32_16x16x32_bf16 v[204:207], v[60:63], v[152:155], v[204:207]
    ds_read_b128 v[52:55], v119 offset:2048
    v_mfma_f32_16x16x32_bf16 v[240:243], v[60:63], v[156:159], v[240:243]
    v_mfma_f32_16x16x32_bf16 v[208:211], v[64:67], v[152:155], v[208:211]
    ds_read_b128 v[56:59], v119 offset:3072
    v_mfma_f32_16x16x32_bf16 v[244:247], v[64:67], v[156:159], v[244:247]
    v_mfma_f32_16x16x32_bf16 v[212:215], v[68:71], v[152:155], v[212:215]
    ds_read_b128 v[60:63], v119 offset:4096
    v_mfma_f32_16x16x32_bf16 v[248:251], v[68:71], v[156:159], v[248:251]
    v_mfma_f32_16x16x32_bf16 v[216:219], v[72:75], v[152:155], v[216:219]
    ds_read_b128 v[64:67], v119 offset:5120
    v_mfma_f32_16x16x32_bf16 v[252:255], v[72:75], v[156:159], v[252:255]
    s_waitcnt vmcnt(2)
    s_waitcnt lgkmcnt(4)
    v_mfma_f32_16x16x32_bf16 v[184:187], v[44:47], v[160:163], v[184:187]
    ds_read_b128 v[68:71], v119 offset:6144
    v_mfma_f32_16x16x32_bf16 v[220:223], v[44:47], v[164:167], v[220:223]
    v_mfma_f32_16x16x32_bf16 v[188:191], v[48:51], v[160:163], v[188:191]
    ds_read_b128 v[72:75], v119 offset:7168
    v_mfma_f32_16x16x32_bf16 v[224:227], v[48:51], v[164:167], v[224:227]
    s_waitcnt lgkmcnt(4)
    v_mfma_f32_16x16x32_bf16 v[192:195], v[52:55], v[160:163], v[192:195]
    ds_read_b128 v[44:47], v119 offset:8192
    v_mfma_f32_16x16x32_bf16 v[228:231], v[52:55], v[164:167], v[228:231]
    v_mfma_f32_16x16x32_bf16 v[196:199], v[56:59], v[160:163], v[196:199]
    ds_read_b128 v[48:51], v119 offset:18432
    v_mfma_f32_16x16x32_bf16 v[232:235], v[56:59], v[164:167], v[232:235]
    s_waitcnt lgkmcnt(4)
    v_mfma_f32_16x16x32_bf16 v[200:203], v[60:63], v[160:163], v[200:203]
    ds_read_b128 v[52:55], v119 offset:19456
    v_mfma_f32_16x16x32_bf16 v[236:239], v[60:63], v[164:167], v[236:239]
    v_mfma_f32_16x16x32_bf16 v[204:207], v[64:67], v[160:163], v[204:207]
    ds_read_b128 v[56:59], v119 offset:20480
    v_mfma_f32_16x16x32_bf16 v[240:243], v[64:67], v[164:167], v[240:243]
    s_waitcnt lgkmcnt(4)
    v_mfma_f32_16x16x32_bf16 v[208:211], v[68:71], v[160:163], v[208:211]
    ds_read_b128 v[60:63], v119 offset:21504
    v_mfma_f32_16x16x32_bf16 v[244:247], v[68:71], v[164:167], v[244:247]
    v_mfma_f32_16x16x32_bf16 v[212:215], v[72:75], v[160:163], v[212:215]
    ds_read_b128 v[64:67], v119 offset:22528
    v_mfma_f32_16x16x32_bf16 v[248:251], v[72:75], v[164:167], v[248:251]
    s_waitcnt lgkmcnt(4)
    v_mfma_f32_16x16x32_bf16 v[216:219], v[44:47], v[160:163], v[216:219]
    ds_read_b128 v[68:71], v119 offset:23552
    v_mfma_f32_16x16x32_bf16 v[252:255], v[44:47], v[164:167], v[252:255]
    s_waitcnt vmcnt(0)
    v_mfma_f32_16x16x32_bf16 v[184:187], v[48:51], v[168:171], v[184:187]
    ds_read_b128 v[72:75], v119 offset:24576
    v_mfma_f32_16x16x32_bf16 v[220:223], v[48:51], v[172:175], v[220:223]
    s_waitcnt lgkmcnt(4)
    v_mfma_f32_16x16x32_bf16 v[188:191], v[52:55], v[168:171], v[188:191]
    ds_read_b128 v[44:47], v119 offset:25600
    v_mfma_f32_16x16x32_bf16 v[224:227], v[52:55], v[172:175], v[224:227]
    v_mfma_f32_16x16x32_bf16 v[192:195], v[56:59], v[168:171], v[192:195]
    ds_read_b128 v[48:51], v119 offset:26624
    v_mfma_f32_16x16x32_bf16 v[228:231], v[56:59], v[172:175], v[228:231]
    s_waitcnt lgkmcnt(4)
    v_mfma_f32_16x16x32_bf16 v[196:199], v[60:63], v[168:171], v[196:199]
    v_mfma_f32_16x16x32_bf16 v[232:235], v[60:63], v[172:175], v[232:235]
    v_mfma_f32_16x16x32_bf16 v[200:203], v[64:67], v[168:171], v[200:203]
    v_mfma_f32_16x16x32_bf16 v[236:239], v[64:67], v[172:175], v[236:239]
    s_waitcnt lgkmcnt(2)
    v_mfma_f32_16x16x32_bf16 v[204:207], v[68:71], v[168:171], v[204:207]
    v_mfma_f32_16x16x32_bf16 v[240:243], v[68:71], v[172:175], v[240:243]
    v_mfma_f32_16x16x32_bf16 v[208:211], v[72:75], v[168:171], v[208:211]
    v_mfma_f32_16x16x32_bf16 v[244:247], v[72:75], v[172:175], v[244:247]
    s_waitcnt lgkmcnt(0)
    v_mfma_f32_16x16x32_bf16 v[212:215], v[44:47], v[168:171], v[212:215]
    v_mfma_f32_16x16x32_bf16 v[248:251], v[44:47], v[172:175], v[248:251]
    v_mfma_f32_16x16x32_bf16 v[216:219], v[48:51], v[168:171], v[216:219]
    v_mfma_f32_16x16x32_bf16 v[252:255], v[48:51], v[172:175], v[252:255]
    s_mul_i32 s33, s28, 9216
    v_lshlrev_b32 v3, 4, v2
    v_add_u32 v4, s33, v3
    s_xor_b32 s34, s28, 4
    s_mul_i32 s34, s34, 9216
    v_add_u32 v5, s34, v3

    v_add_u32 v4, 73728, v4
    v_add_u32 v5, 73728, v5
    s_cmp_eq_u32 s57, 0
    s_cbranch_scc1 kd_h0_32

    ds_write_b128 v4, v[184:187] offset:0
    ds_write_b128 v4, v[188:191] offset:1024
    ds_write_b128 v4, v[192:195] offset:2048
    ds_write_b128 v4, v[196:199] offset:3072
    ds_write_b128 v4, v[200:203] offset:4096
    ds_write_b128 v4, v[204:207] offset:5120
    ds_write_b128 v4, v[208:211] offset:6144
    ds_write_b128 v4, v[212:215] offset:7168
    ds_write_b128 v4, v[216:219] offset:8192
    v_mov_b32 v184, v220
    v_mov_b32 v185, v221
    v_mov_b32 v186, v222
    v_mov_b32 v187, v223
    v_mov_b32 v188, v224
    v_mov_b32 v189, v225
    v_mov_b32 v190, v226
    v_mov_b32 v191, v227
    v_mov_b32 v192, v228
    v_mov_b32 v193, v229
    v_mov_b32 v194, v230
    v_mov_b32 v195, v231
    v_mov_b32 v196, v232
    v_mov_b32 v197, v233
    v_mov_b32 v198, v234
    v_mov_b32 v199, v235
    v_mov_b32 v200, v236
    v_mov_b32 v201, v237
    v_mov_b32 v202, v238
    v_mov_b32 v203, v239
    v_mov_b32 v204, v240
    v_mov_b32 v205, v241
    v_mov_b32 v206, v242
    v_mov_b32 v207, v243
    v_mov_b32 v208, v244
    v_mov_b32 v209, v245
    v_mov_b32 v210, v246
    v_mov_b32 v211, v247
    v_mov_b32 v212, v248
    v_mov_b32 v213, v249
    v_mov_b32 v214, v250
    v_mov_b32 v215, v251
    v_mov_b32 v216, v252
    v_mov_b32 v217, v253
    v_mov_b32 v218, v254
    v_mov_b32 v219, v255
    s_branch kd_hj_33
kd_h0_32:
    ds_write_b128 v4, v[220:223] offset:0
    ds_write_b128 v4, v[224:227] offset:1024
    ds_write_b128 v4, v[228:231] offset:2048
    ds_write_b128 v4, v[232:235] offset:3072
    ds_write_b128 v4, v[236:239] offset:4096
    ds_write_b128 v4, v[240:243] offset:5120
    ds_write_b128 v4, v[244:247] offset:6144
    ds_write_b128 v4, v[248:251] offset:7168
    ds_write_b128 v4, v[252:255] offset:8192
kd_hj_33:
    s_waitcnt lgkmcnt(0)
    s_barrier
    ds_read_b128 v[40:43], v5 offset:0
    ds_read_b128 v[44:47], v5 offset:1024
    ds_read_b128 v[48:51], v5 offset:2048
    ds_read_b128 v[52:55], v5 offset:3072
    ds_read_b128 v[56:59], v5 offset:4096
    ds_read_b128 v[60:63], v5 offset:5120
    ds_read_b128 v[64:67], v5 offset:6144
    ds_read_b128 v[68:71], v5 offset:7168
    ds_read_b128 v[72:75], v5 offset:8192
    s_lshl_b32 s42, s53, 2
    s_add_u32 s42, s42, s54
    s_lshl_b32 s42, s42, 2
    s_add_u32 s43, s42, s56
    s_lshl_b32 s43, s43, 2
    s_add_u32 s43, s43, s52
    s_mul_i32 s44, s43, 9216
    s_lshl_b32 s33, s57, 8
    s_add_u32 s44, s44, s33
    v_and_b32 v6, 15, v2
    v_lshlrev_b32 v6, 4, v6
    v_bfe_u32 v7, v2, 4, 1
    v_lshl_add_u32 v8, v7, 10, v6
    v_lshrrev_b32 v24, 5, v2
    v_lshl_add_u32 v8, v24, 9, v8
    v_lshl_add_u32 v6, v24, 9, v6
    v_lshl_add_u32 v6, v7, 3, v6
    s_add_u32 s45, s44, 4096
    s_add_u32 s46, s44, 8192

    s_waitcnt lgkmcnt(8)
    v_pk_add_f32 v[184:185], v[184:185], v[40:41]
    v_pk_add_f32 v[186:187], v[186:187], v[42:43]
    v_cvt_pk_bf16_f32 v80, v184, v185
    v_cvt_pk_bf16_f32 v81, v186, v187
    s_waitcnt lgkmcnt(7)
    v_pk_add_f32 v[188:189], v[188:189], v[44:45]
    v_pk_add_f32 v[190:191], v[190:191], v[46:47]
    v_cvt_pk_bf16_f32 v82, v188, v189
    v_cvt_pk_bf16_f32 v83, v190, v191
    s_waitcnt lgkmcnt(6)
    v_pk_add_f32 v[192:193], v[192:193], v[48:49]
    v_pk_add_f32 v[194:195], v[194:195], v[50:51]
    v_cvt_pk_bf16_f32 v84, v192, v193
    v_cvt_pk_bf16_f32 v85, v194, v195
    v_permlane16_swap_b32 v80, v82
    v_permlane16_swap_b32 v81, v83
    s_waitcnt lgkmcnt(5)
    v_pk_add_f32 v[196:197], v[196:197], v[52:53]
    v_pk_add_f32 v[198:199], v[198:199], v[54:55]
    v_cvt_pk_bf16_f32 v86, v196, v197
    v_cvt_pk_bf16_f32 v87, v198, v199
    s_waitcnt lgkmcnt(4)
    v_pk_add_f32 v[200:201], v[200:201], v[56:57]
    v_pk_add_f32 v[202:203], v[202:203], v[58:59]
    v_cvt_pk_bf16_f32 v88, v200, v201
    v_cvt_pk_bf16_f32 v89, v202, v203
    v_permlane16_swap_b32 v84, v86
    v_permlane16_swap_b32 v85, v87
    s_waitcnt lgkmcnt(3)
    v_pk_add_f32 v[204:205], v[204:205], v[60:61]
    v_pk_add_f32 v[206:207], v[206:207], v[62:63]
    v_cvt_pk_bf16_f32 v90, v204, v205
    v_cvt_pk_bf16_f32 v91, v206, v207
    s_waitcnt lgkmcnt(2)
    v_pk_add_f32 v[208:209], v[208:209], v[64:65]
    v_pk_add_f32 v[210:211], v[210:211], v[66:67]
    v_cvt_pk_bf16_f32 v92, v208, v209
    v_cvt_pk_bf16_f32 v93, v210, v211
    v_permlane16_swap_b32 v88, v90
    v_permlane16_swap_b32 v89, v91
    s_waitcnt lgkmcnt(1)
    v_pk_add_f32 v[212:213], v[212:213], v[68:69]
    v_pk_add_f32 v[214:215], v[214:215], v[70:71]
    v_cvt_pk_bf16_f32 v94, v212, v213
    v_cvt_pk_bf16_f32 v95, v214, v215
    s_waitcnt lgkmcnt(0)
    v_pk_add_f32 v[216:217], v[216:217], v[72:73]
    v_pk_add_f32 v[218:219], v[218:219], v[74:75]
    v_cvt_pk_bf16_f32 v96, v216, v217
    v_cvt_pk_bf16_f32 v97, v218, v219
    v_permlane16_swap_b32 v92, v94
    v_permlane16_swap_b32 v93, v95
    s_cmp_eq_u32 s56, s52
    s_cbranch_scc1 kd_own_34
    buffer_store_dwordx4 v[80:83], v8, s[60:63], s44 offen offset:0 sc1
    buffer_store_dwordx4 v[84:87], v8, s[60:63], s44 offen offset:2048 sc1
    buffer_store_dwordx4 v[88:91], v8, s[60:63], s45 offen offset:0 sc1
    buffer_store_dwordx4 v[92:95], v8, s[60:63], s45 offen offset:2048 sc1
    buffer_store_dwordx2 v[96:97], v6, s[60:63], s46 offen sc1
    s_branch kd_oe_35
kd_own_34:
    v_add_u32 v8, s33, v8
    v_add_u32 v6, s33, v6
    ds_write_b128 v8, v[80:83] offset:0
    ds_write_b128 v8, v[84:87] offset:2048
    ds_write_b128 v8, v[88:91] offset:4096
    ds_write_b128 v8, v[92:95] offset:6144
    ds_write_b64 v6, v[96:97] offset:8192
kd_oe_35:
    s_load_dwordx2 s[4:5], s[0:1], 80
    v_lshlrev_b32 v20, 4, v0
    v_lshrrev_b32 v4, 5, v0
    v_and_b32 v5, 31, v0
    s_lshl_b32 s33, s53, 7
    s_lshl_b32 s34, s52, 5
    s_add_u32 s33, s33, s34
    v_add_u32 v5, s33, v5
    s_mul_i32 s34, s54, 18
    v_add_u32 v4, s34, v4
    v_lshlrev_b32 v21, 15, v4
    v_lshl_add_u32 v21, v5, 4, v21
    s_movk_i32 s35, 1152
    v_mul_lo_u32 v22, v5, s35
    v_lshl_add_u32 v22, v4, 4, v22
    s_add_u32 s45, s42, s56
    s_lshl_b32 s45, s45, 7
    s_lshl_b32 s33, s52, 3
    s_add_u32 s45, s45, s33
    s_lshl_b32 s33, s57, 2
    s_add_u32 s45, s45, s33
    s_add_u32 s45, s45, 9446400
    v_mov_b32 v23, 1
    v_mov_b32 v24, 0
    s_add_u32 s46, s42, s52
    s_lshl_b32 s47, s46, 7
    s_add_u32 s47, s47, 9446400
    s_mul_i32 s46, s46, 36864
    v_and_b32 v25, 7, v2
    v_lshlrev_b32 v25, 2, v25
    s_mov_b32 s34, 294912
    s_waitcnt vmcnt(0) lgkmcnt(0)
    s_mov_b64 exec, 1
    buffer_store_dword v23, v24, s[60:63], s45 offen sc1
    s_mov_b64 exec, -1
    s_mov_b32 s6, 0x240000
    s_cmp_ge_u32 s28, 5
    s_cbranch_scc1 kc_fin
    buffer_load_dwordx4 v[28:31], v21, s[12:15], 0 offen
    buffer_load_dwordx4 v[32:35], v21, s[12:15], s34 offen
    s_cmp_lg_u32 s28, 0
    s_cbranch_scc1 kc_go
    s_mov_b32 s67, 0

kc_poll:
    buffer_load_dword v26, v25, s[60:63], s47 offen sc1
    s_add_u32 s67, s67, 1
    s_waitcnt vmcnt(0)
    v_cmp_ne_u32 vcc, 1, v26
    s_cmp_ge_u32 s67, 0x8000
    s_cbranch_scc1 kc_go
    s_cbranch_vccnz kc_poll

kc_go:
    s_barrier
    v_cmp_gt_u32 vcc, 288, v0
    s_and_saveexec_b64 s[58:59], vcc

    s_add_u32 s33, s52, 1
    s_and_b32 s33, s33, 3
    s_mul_i32 s33, s33, 9216
    s_add_u32 s33, s33, s46
    buffer_load_dwordx4 v[40:43], v20, s[60:63], s33 offen sc1
    s_add_u32 s34, s33, 4608
    buffer_load_dwordx4 v[44:47], v20, s[60:63], s34 offen sc1
    s_add_u32 s33, s52, 2
    s_and_b32 s33, s33, 3
    s_mul_i32 s33, s33, 9216
    s_add_u32 s33, s33, s46
    buffer_load_dwordx4 v[48:51], v20, s[60:63], s33 offen sc1
    s_add_u32 s34, s33, 4608
    buffer_load_dwordx4 v[52:55], v20, s[60:63], s34 offen sc1
    s_add_u32 s33, s52, 3
    s_and_b32 s33, s33, 3
    s_mul_i32 s33, s33, 9216
    s_add_u32 s33, s33, s46
    buffer_load_dwordx4 v[56:59], v20, s[60:63], s33 offen sc1
    s_add_u32 s34, s33, 4608
    buffer_load_dwordx4 v[60:63], v20, s[60:63], s34 offen sc1
    ds_read_b128 v[64:67], v20
    ds_read_b128 v[68:71], v20 offset:4608
    s_mov_b32 s40, 0xffff0000
    s_waitcnt vmcnt(6)
    v_lshlrev_b32 v104, 16, v28
    v_and_b32 v105, s40, v28
    v_lshlrev_b32 v106, 16, v29
    v_and_b32 v107, s40, v29
    v_lshlrev_b32 v108, 16, v30
    v_and_b32 v109, s40, v30
    v_lshlrev_b32 v110, 16, v31
    v_and_b32 v111, s40, v31
    v_lshlrev_b32 v112, 16, v32
    v_and_b32 v113, s40, v32
    v_lshlrev_b32 v114, 16, v33
    v_and_b32 v115, s40, v33
    v_lshlrev_b32 v116, 16, v34
    v_and_b32 v117, s40, v34
    v_lshlrev_b32 v118, 16, v35
    v_and_b32 v119, s40, v35
    s_waitcnt lgkmcnt(0)
    v_lshlrev_b32 v120, 16, v64
    v_and_b32 v121, s40, v64
    v_pk_add_f32 v[104:105], v[104:105], v[120:121]
    v_lshlrev_b32 v120, 16, v65
    v_and_b32 v121, s40, v65
    v_pk_add_f32 v[106:107], v[106:107], v[120:121]
    v_lshlrev_b32 v120, 16, v66
    v_and_b32 v121, s40, v66
    v_pk_add_f32 v[108:109], v[108:109], v[120:121]
    v_lshlrev_b32 v120, 16, v67
    v_and_b32 v121, s40, v67
    v_pk_add_f32 v[110:111], v[110:111], v[120:121]
    v_lshlrev_b32 v120, 16, v68
    v_and_b32 v121, s40, v68
    v_pk_add_f32 v[112:113], v[112:113], v[120:121]
    v_lshlrev_b32 v120, 16, v69
    v_and_b32 v121, s40, v69
    v_pk_add_f32 v[114:115], v[114:115], v[120:121]
    v_lshlrev_b32 v120, 16, v70
    v_and_b32 v121, s40, v70
    v_pk_add_f32 v[116:117], v[116:117], v[120:121]
    v_lshlrev_b32 v120, 16, v71
    v_and_b32 v121, s40, v71
    v_pk_add_f32 v[118:119], v[118:119], v[120:121]
    s_waitcnt vmcnt(4)
    v_lshlrev_b32 v120, 16, v40
    v_and_b32 v121, s40, v40
    v_pk_add_f32 v[104:105], v[104:105], v[120:121]
    v_lshlrev_b32 v120, 16, v41
    v_and_b32 v121, s40, v41
    v_pk_add_f32 v[106:107], v[106:107], v[120:121]
    v_lshlrev_b32 v120, 16, v42
    v_and_b32 v121, s40, v42
    v_pk_add_f32 v[108:109], v[108:109], v[120:121]
    v_lshlrev_b32 v120, 16, v43
    v_and_b32 v121, s40, v43
    v_pk_add_f32 v[110:111], v[110:111], v[120:121]
    v_lshlrev_b32 v120, 16, v44
    v_and_b32 v121, s40, v44
    v_pk_add_f32 v[112:113], v[112:113], v[120:121]
    v_lshlrev_b32 v120, 16, v45
    v_and_b32 v121, s40, v45
    v_pk_add_f32 v[114:115], v[114:115], v[120:121]
    v_lshlrev_b32 v120, 16, v46
    v_and_b32 v121, s40, v46
    v_pk_add_f32 v[116:117], v[116:117], v[120:121]
    v_lshlrev_b32 v120, 16, v47
    v_and_b32 v121, s40, v47
    v_pk_add_f32 v[118:119], v[118:119], v[120:121]
    s_waitcnt vmcnt(2)
    v_lshlrev_b32 v120, 16, v48
    v_and_b32 v121, s40, v48
    v_pk_add_f32 v[104:105], v[104:105], v[120:121]
    v_lshlrev_b32 v120, 16, v49
    v_and_b32 v121, s40, v49
    v_pk_add_f32 v[106:107], v[106:107], v[120:121]
    v_lshlrev_b32 v120, 16, v50
    v_and_b32 v121, s40, v50
    v_pk_add_f32 v[108:109], v[108:109], v[120:121]
    v_lshlrev_b32 v120, 16, v51
    v_and_b32 v121, s40, v51
    v_pk_add_f32 v[110:111], v[110:111], v[120:121]
    v_lshlrev_b32 v120, 16, v52
    v_and_b32 v121, s40, v52
    v_pk_add_f32 v[112:113], v[112:113], v[120:121]
    v_lshlrev_b32 v120, 16, v53
    v_and_b32 v121, s40, v53
    v_pk_add_f32 v[114:115], v[114:115], v[120:121]
    v_lshlrev_b32 v120, 16, v54
    v_and_b32 v121, s40, v54
    v_pk_add_f32 v[116:117], v[116:117], v[120:121]
    v_lshlrev_b32 v120, 16, v55
    v_and_b32 v121, s40, v55
    v_pk_add_f32 v[118:119], v[118:119], v[120:121]
    s_waitcnt vmcnt(0)
    v_lshlrev_b32 v120, 16, v56
    v_and_b32 v121, s40, v56
    v_pk_add_f32 v[104:105], v[104:105], v[120:121]
    v_lshlrev_b32 v120, 16, v57
    v_and_b32 v121, s40, v57
    v_pk_add_f32 v[106:107], v[106:107], v[120:121]
    v_lshlrev_b32 v120, 16, v58
    v_and_b32 v121, s40, v58
    v_pk_add_f32 v[108:109], v[108:109], v[120:121]
    v_lshlrev_b32 v120, 16, v59
    v_and_b32 v121, s40, v59
    v_pk_add_f32 v[110:111], v[110:111], v[120:121]
    v_lshlrev_b32 v120, 16, v60
    v_and_b32 v121, s40, v60
    v_pk_add_f32 v[112:113], v[112:113], v[120:121]
    v_lshlrev_b32 v120, 16, v61
    v_and_b32 v121, s40, v61
    v_pk_add_f32 v[114:115], v[114:115], v[120:121]
    v_lshlrev_b32 v120, 16, v62
    v_and_b32 v121, s40, v62
    v_pk_add_f32 v[116:117], v[116:117], v[120:121]
    v_lshlrev_b32 v120, 16, v63
    v_and_b32 v121, s40, v63
    v_pk_add_f32 v[118:119], v[118:119], v[120:121]
    v_cvt_pk_bf16_f32 v28, v104, v105
    v_cvt_pk_bf16_f32 v29, v106, v107
    v_cvt_pk_bf16_f32 v30, v108, v109
    v_cvt_pk_bf16_f32 v31, v110, v111
    v_cvt_pk_bf16_f32 v32, v112, v113
    v_cvt_pk_bf16_f32 v33, v114, v115
    v_cvt_pk_bf16_f32 v34, v116, v117
    v_cvt_pk_bf16_f32 v35, v118, v119
    buffer_store_dwordx4 v[28:31], v22, s[4:7], 0 offen
    buffer_store_dwordx4 v[32:35], v22, s[4:7], 0 offen offset:144
    s_mov_b64 exec, s[58:59]
kc_fin:
kc_done:
    s_endpgm
kc_slowstat:
    v_mov_b32 v16, 0
    v_mov_b32 v17, 0
    v_mov_b32 v18, 0
    v_mov_b32 v19, 0
    v_mov_b32 v20, 0
    v_mov_b32 v21, 0
    v_mov_b32 v22, 0
    v_mov_b32 v23, 0
    v_lshlrev_b32 v4, 16, v112
    v_and_b32 v5, s47, v112
    v_add_f32 v16, v16, v4
    v_add_f32 v17, v17, v5
    v_fmac_f32 v18, v4, v4
    v_fmac_f32 v19, v5, v5
    v_lshlrev_b32 v4, 16, v113
    v_and_b32 v5, s47, v113
    v_add_f32 v16, v16, v4
    v_add_f32 v17, v17, v5
    v_fmac_f32 v18, v4, v4
    v_fmac_f32 v19, v5, v5
    v_lshlrev_b32 v4, 16, v114
    v_and_b32 v5, s47, v114
    v_add_f32 v16, v16, v4
    v_add_f32 v17, v17, v5
    v_fmac_f32 v18, v4, v4
    v_fmac_f32 v19, v5, v5
    v_lshlrev_b32 v4, 16, v115
    v_and_b32 v5, s47, v115
    v_add_f32 v16, v16, v4
    v_add_f32 v17, v17, v5
    v_fmac_f32 v18, v4, v4
    v_fmac_f32 v19, v5, v5
    v_lshlrev_b32 v4, 16, v116
    v_and_b32 v5, s47, v116
    v_add_f32 v20, v20, v4
    v_add_f32 v21, v21, v5
    v_fmac_f32 v22, v4, v4
    v_fmac_f32 v23, v5, v5
    v_lshlrev_b32 v4, 16, v117
    v_and_b32 v5, s47, v117
    v_add_f32 v20, v20, v4
    v_add_f32 v21, v21, v5
    v_fmac_f32 v22, v4, v4
    v_fmac_f32 v23, v5, v5
    v_lshlrev_b32 v4, 16, v118
    v_and_b32 v5, s47, v118
    v_add_f32 v20, v20, v4
    v_add_f32 v21, v21, v5
    v_fmac_f32 v22, v4, v4
    v_fmac_f32 v23, v5, v5
    v_lshlrev_b32 v4, 16, v119
    v_and_b32 v5, s47, v119
    v_add_f32 v20, v20, v4
    v_add_f32 v21, v21, v5
    v_fmac_f32 v22, v4, v4
    v_fmac_f32 v23, v5, v5
    v_lshlrev_b32 v4, 16, v120
    v_and_b32 v5, s47, v120
    v_add_f32 v16, v16, v4
    v_add_f32 v17, v17, v5
    v_fmac_f32 v18, v4, v4
    v_fmac_f32 v19, v5, v5
    v_lshlrev_b32 v4, 16, v121
    v_and_b32 v5, s47, v121
    v_add_f32 v16, v16, v4
    v_add_f32 v17, v17, v5
    v_fmac_f32 v18, v4, v4
    v_fmac_f32 v19, v5, v5
    v_lshlrev_b32 v4, 16, v122
    v_and_b32 v5, s47, v122
    v_add_f32 v16, v16, v4
    v_add_f32 v17, v17, v5
    v_fmac_f32 v18, v4, v4
    v_fmac_f32 v19, v5, v5
    v_lshlrev_b32 v4, 16, v123
    v_and_b32 v5, s47, v123
    v_add_f32 v16, v16, v4
    v_add_f32 v17, v17, v5
    v_fmac_f32 v18, v4, v4
    v_fmac_f32 v19, v5, v5
    v_lshlrev_b32 v4, 16, v124
    v_and_b32 v5, s47, v124
    v_add_f32 v20, v20, v4
    v_add_f32 v21, v21, v5
    v_fmac_f32 v22, v4, v4
    v_fmac_f32 v23, v5, v5
    v_lshlrev_b32 v4, 16, v125
    v_and_b32 v5, s47, v125
    v_add_f32 v20, v20, v4
    v_add_f32 v21, v21, v5
    v_fmac_f32 v22, v4, v4
    v_fmac_f32 v23, v5, v5
    v_lshlrev_b32 v4, 16, v126
    v_and_b32 v5, s47, v126
    v_add_f32 v20, v20, v4
    v_add_f32 v21, v21, v5
    v_fmac_f32 v22, v4, v4
    v_fmac_f32 v23, v5, v5
    v_lshlrev_b32 v4, 16, v127
    v_and_b32 v5, s47, v127
    v_add_f32 v20, v20, v4
    v_add_f32 v21, v21, v5
    v_fmac_f32 v22, v4, v4
    v_fmac_f32 v23, v5, v5
    v_lshlrev_b32 v4, 16, v128
    v_and_b32 v5, s47, v128
    v_add_f32 v16, v16, v4
    v_add_f32 v17, v17, v5
    v_fmac_f32 v18, v4, v4
    v_fmac_f32 v19, v5, v5
    v_lshlrev_b32 v4, 16, v129
    v_and_b32 v5, s47, v129
    v_add_f32 v16, v16, v4
    v_add_f32 v17, v17, v5
    v_fmac_f32 v18, v4, v4
    v_fmac_f32 v19, v5, v5
    v_lshlrev_b32 v4, 16, v130
    v_and_b32 v5, s47, v130
    v_add_f32 v16, v16, v4
    v_add_f32 v17, v17, v5
    v_fmac_f32 v18, v4, v4
    v_fmac_f32 v19, v5, v5
    v_lshlrev_b32 v4, 16, v131
    v_and_b32 v5, s47, v131
    v_add_f32 v16, v16, v4
    v_add_f32 v17, v17, v5
    v_fmac_f32 v18, v4, v4
    v_fmac_f32 v19, v5, v5
    v_lshlrev_b32 v4, 16, v132
    v_and_b32 v5, s47, v132
    v_add_f32 v20, v20, v4
    v_add_f32 v21, v21, v5
    v_fmac_f32 v22, v4, v4
    v_fmac_f32 v23, v5, v5
    v_lshlrev_b32 v4, 16, v133
    v_and_b32 v5, s47, v133
    v_add_f32 v20, v20, v4
    v_add_f32 v21, v21, v5
    v_fmac_f32 v22, v4, v4
    v_fmac_f32 v23, v5, v5
    v_lshlrev_b32 v4, 16, v134
    v_and_b32 v5, s47, v134
    v_add_f32 v20, v20, v4
    v_add_f32 v21, v21, v5
    v_fmac_f32 v22, v4, v4
    v_fmac_f32 v23, v5, v5
    v_lshlrev_b32 v4, 16, v135
    v_and_b32 v5, s47, v135
    v_add_f32 v20, v20, v4
    v_add_f32 v21, v21, v5
    v_fmac_f32 v22, v4, v4
    v_fmac_f32 v23, v5, v5
    v_lshlrev_b32 v4, 16, v136
    v_and_b32 v5, s47, v136
    v_add_f32 v16, v16, v4
    v_add_f32 v17, v17, v5
    v_fmac_f32 v18, v4, v4
    v_fmac_f32 v19, v5, v5
    v_lshlrev_b32 v4, 16, v137
    v_and_b32 v5, s47, v137
    v_add_f32 v16, v16, v4
    v_add_f32 v17, v17, v5
    v_fmac_f32 v18, v4, v4
    v_fmac_f32 v19, v5, v5
    v_lshlrev_b32 v4, 16, v138
    v_and_b32 v5, s47, v138
    v_add_f32 v16, v16, v4
    v_add_f32 v17, v17, v5
    v_fmac_f32 v18, v4, v4
    v_fmac_f32 v19, v5, v5
    v_lshlrev_b32 v4, 16, v139
    v_and_b32 v5, s47, v139
    v_add_f32 v16, v16, v4
    v_add_f32 v17, v17, v5
    v_fmac_f32 v18, v4, v4
    v_fmac_f32 v19, v5, v5
    v_lshlrev_b32 v4, 16, v140
    v_and_b32 v5, s47, v140
    v_add_f32 v20, v20, v4
    v_add_f32 v21, v21, v5
    v_fmac_f32 v22, v4, v4
    v_fmac_f32 v23, v5, v5
    v_lshlrev_b32 v4, 16, v141
    v_and_b32 v5, s47, v141
    v_add_f32 v20, v20, v4
    v_add_f32 v21, v21, v5
    v_fmac_f32 v22, v4, v4
    v_fmac_f32 v23, v5, v5
    v_lshlrev_b32 v4, 16, v142
    v_and_b32 v5, s47, v142
    v_add_f32 v20, v20, v4
    v_add_f32 v21, v21, v5
    v_fmac_f32 v22, v4, v4
    v_fmac_f32 v23, v5, v5
    v_lshlrev_b32 v4, 16, v143
    v_and_b32 v5, s47, v143
    v_add_f32 v20, v20, v4
    v_add_f32 v21, v21, v5
    v_fmac_f32 v22, v4, v4
    v_fmac_f32 v23, v5, v5
    v_lshlrev_b32 v4, 16, v144
    v_and_b32 v5, s47, v144
    v_add_f32 v16, v16, v4
    v_add_f32 v17, v17, v5
    v_fmac_f32 v18, v4, v4
    v_fmac_f32 v19, v5, v5
    v_lshlrev_b32 v4, 16, v145
    v_and_b32 v5, s47, v145
    v_add_f32 v16, v16, v4
    v_add_f32 v17, v17, v5
    v_fmac_f32 v18, v4, v4
    v_fmac_f32 v19, v5, v5
    v_lshlrev_b32 v4, 16, v146
    v_and_b32 v5, s47, v146
    v_add_f32 v16, v16, v4
    v_add_f32 v17, v17, v5
    v_fmac_f32 v18, v4, v4
    v_fmac_f32 v19, v5, v5
    v_lshlrev_b32 v4, 16, v147
    v_and_b32 v5, s47, v147
    v_add_f32 v16, v16, v4
    v_add_f32 v17, v17, v5
    v_fmac_f32 v18, v4, v4
    v_fmac_f32 v19, v5, v5
    v_lshlrev_b32 v4, 16, v148
    v_and_b32 v5, s47, v148
    v_add_f32 v20, v20, v4
    v_add_f32 v21, v21, v5
    v_fmac_f32 v22, v4, v4
    v_fmac_f32 v23, v5, v5
    v_lshlrev_b32 v4, 16, v149
    v_and_b32 v5, s47, v149
    v_add_f32 v20, v20, v4
    v_add_f32 v21, v21, v5
    v_fmac_f32 v22, v4, v4
    v_fmac_f32 v23, v5, v5
    v_lshlrev_b32 v4, 16, v150
    v_and_b32 v5, s47, v150
    v_add_f32 v20, v20, v4
    v_add_f32 v21, v21, v5
    v_fmac_f32 v22, v4, v4
    v_fmac_f32 v23, v5, v5
    v_lshlrev_b32 v4, 16, v151
    v_and_b32 v5, s47, v151
    v_add_f32 v20, v20, v4
    v_add_f32 v21, v21, v5
    v_fmac_f32 v22, v4, v4
    v_fmac_f32 v23, v5, v5
    v_lshlrev_b32 v4, 16, v152
    v_and_b32 v5, s47, v152
    v_add_f32 v16, v16, v4
    v_add_f32 v17, v17, v5
    v_fmac_f32 v18, v4, v4
    v_fmac_f32 v19, v5, v5
    v_lshlrev_b32 v4, 16, v153
    v_and_b32 v5, s47, v153
    v_add_f32 v16, v16, v4
    v_add_f32 v17, v17, v5
    v_fmac_f32 v18, v4, v4
    v_fmac_f32 v19, v5, v5
    v_lshlrev_b32 v4, 16, v154
    v_and_b32 v5, s47, v154
    v_add_f32 v16, v16, v4
    v_add_f32 v17, v17, v5
    v_fmac_f32 v18, v4, v4
    v_fmac_f32 v19, v5, v5
    v_lshlrev_b32 v4, 16, v155
    v_and_b32 v5, s47, v155
    v_add_f32 v16, v16, v4
    v_add_f32 v17, v17, v5
    v_fmac_f32 v18, v4, v4
    v_fmac_f32 v19, v5, v5
    v_lshlrev_b32 v4, 16, v156
    v_and_b32 v5, s47, v156
    v_add_f32 v20, v20, v4
    v_add_f32 v21, v21, v5
    v_fmac_f32 v22, v4, v4
    v_fmac_f32 v23, v5, v5
    v_lshlrev_b32 v4, 16, v157
    v_and_b32 v5, s47, v157
    v_add_f32 v20, v20, v4
    v_add_f32 v21, v21, v5
    v_fmac_f32 v22, v4, v4
    v_fmac_f32 v23, v5, v5
    v_lshlrev_b32 v4, 16, v158
    v_and_b32 v5, s47, v158
    v_add_f32 v20, v20, v4
    v_add_f32 v21, v21, v5
    v_fmac_f32 v22, v4, v4
    v_fmac_f32 v23, v5, v5
    v_lshlrev_b32 v4, 16, v159
    v_and_b32 v5, s47, v159
    v_add_f32 v20, v20, v4
    v_add_f32 v21, v21, v5
    v_fmac_f32 v22, v4, v4
    v_fmac_f32 v23, v5, v5
    v_lshlrev_b32 v4, 16, v160
    v_and_b32 v5, s47, v160
    v_add_f32 v16, v16, v4
    v_add_f32 v17, v17, v5
    v_fmac_f32 v18, v4, v4
    v_fmac_f32 v19, v5, v5
    v_lshlrev_b32 v4, 16, v161
    v_and_b32 v5, s47, v161
    v_add_f32 v16, v16, v4
    v_add_f32 v17, v17, v5
    v_fmac_f32 v18, v4, v4
    v_fmac_f32 v19, v5, v5
    v_lshlrev_b32 v4, 16, v162
    v_and_b32 v5, s47, v162
    v_add_f32 v16, v16, v4
    v_add_f32 v17, v17, v5
    v_fmac_f32 v18, v4, v4
    v_fmac_f32 v19, v5, v5
    v_lshlrev_b32 v4, 16, v163
    v_and_b32 v5, s47, v163
    v_add_f32 v16, v16, v4
    v_add_f32 v17, v17, v5
    v_fmac_f32 v18, v4, v4
    v_fmac_f32 v19, v5, v5
    v_lshlrev_b32 v4, 16, v164
    v_and_b32 v5, s47, v164
    v_add_f32 v20, v20, v4
    v_add_f32 v21, v21, v5
    v_fmac_f32 v22, v4, v4
    v_fmac_f32 v23, v5, v5
    v_lshlrev_b32 v4, 16, v165
    v_and_b32 v5, s47, v165
    v_add_f32 v20, v20, v4
    v_add_f32 v21, v21, v5
    v_fmac_f32 v22, v4, v4
    v_fmac_f32 v23, v5, v5
    v_lshlrev_b32 v4, 16, v166
    v_and_b32 v5, s47, v166
    v_add_f32 v20, v20, v4
    v_add_f32 v21, v21, v5
    v_fmac_f32 v22, v4, v4
    v_fmac_f32 v23, v5, v5
    v_lshlrev_b32 v4, 16, v167
    v_and_b32 v5, s47, v167
    v_add_f32 v20, v20, v4
    v_add_f32 v21, v21, v5
    v_fmac_f32 v22, v4, v4
    v_fmac_f32 v23, v5, v5
    v_lshlrev_b32 v4, 16, v168
    v_and_b32 v5, s47, v168
    v_add_f32 v16, v16, v4
    v_add_f32 v17, v17, v5
    v_fmac_f32 v18, v4, v4
    v_fmac_f32 v19, v5, v5
    v_lshlrev_b32 v4, 16, v169
    v_and_b32 v5, s47, v169
    v_add_f32 v16, v16, v4
    v_add_f32 v17, v17, v5
    v_fmac_f32 v18, v4, v4
    v_fmac_f32 v19, v5, v5
    v_lshlrev_b32 v4, 16, v170
    v_and_b32 v5, s47, v170
    v_add_f32 v16, v16, v4
    v_add_f32 v17, v17, v5
    v_fmac_f32 v18, v4, v4
    v_fmac_f32 v19, v5, v5
    v_lshlrev_b32 v4, 16, v171
    v_and_b32 v5, s47, v171
    v_add_f32 v16, v16, v4
    v_add_f32 v17, v17, v5
    v_fmac_f32 v18, v4, v4
    v_fmac_f32 v19, v5, v5
    v_lshlrev_b32 v4, 16, v172
    v_and_b32 v5, s47, v172
    v_add_f32 v20, v20, v4
    v_add_f32 v21, v21, v5
    v_fmac_f32 v22, v4, v4
    v_fmac_f32 v23, v5, v5
    v_lshlrev_b32 v4, 16, v173
    v_and_b32 v5, s47, v173
    v_add_f32 v20, v20, v4
    v_add_f32 v21, v21, v5
    v_fmac_f32 v22, v4, v4
    v_fmac_f32 v23, v5, v5
    v_lshlrev_b32 v4, 16, v174
    v_and_b32 v5, s47, v174
    v_add_f32 v20, v20, v4
    v_add_f32 v21, v21, v5
    v_fmac_f32 v22, v4, v4
    v_fmac_f32 v23, v5, v5
    v_lshlrev_b32 v4, 16, v175
    v_and_b32 v5, s47, v175
    v_add_f32 v20, v20, v4
    v_add_f32 v21, v21, v5
    v_fmac_f32 v22, v4, v4
    v_fmac_f32 v23, v5, v5
    v_lshlrev_b32 v4, 16, v176
    v_and_b32 v5, s47, v176
    v_add_f32 v16, v16, v4
    v_add_f32 v17, v17, v5
    v_fmac_f32 v18, v4, v4
    v_fmac_f32 v19, v5, v5
    v_lshlrev_b32 v4, 16, v177
    v_and_b32 v5, s47, v177
    v_add_f32 v16, v16, v4
    v_add_f32 v17, v17, v5
    v_fmac_f32 v18, v4, v4
    v_fmac_f32 v19, v5, v5
    v_lshlrev_b32 v4, 16, v178
    v_and_b32 v5, s47, v178
    v_add_f32 v16, v16, v4
    v_add_f32 v17, v17, v5
    v_fmac_f32 v18, v4, v4
    v_fmac_f32 v19, v5, v5
    v_lshlrev_b32 v4, 16, v179
    v_and_b32 v5, s47, v179
    v_add_f32 v16, v16, v4
    v_add_f32 v17, v17, v5
    v_fmac_f32 v18, v4, v4
    v_fmac_f32 v19, v5, v5
    v_lshlrev_b32 v4, 16, v180
    v_and_b32 v5, s47, v180
    v_add_f32 v20, v20, v4
    v_add_f32 v21, v21, v5
    v_fmac_f32 v22, v4, v4
    v_fmac_f32 v23, v5, v5
    v_lshlrev_b32 v4, 16, v181
    v_and_b32 v5, s47, v181
    v_add_f32 v20, v20, v4
    v_add_f32 v21, v21, v5
    v_fmac_f32 v22, v4, v4
    v_fmac_f32 v23, v5, v5
    v_lshlrev_b32 v4, 16, v182
    v_and_b32 v5, s47, v182
    v_add_f32 v20, v20, v4
    v_add_f32 v21, v21, v5
    v_fmac_f32 v22, v4, v4
    v_fmac_f32 v23, v5, v5
    v_lshlrev_b32 v4, 16, v183
    v_and_b32 v5, s47, v183
    v_add_f32 v20, v20, v4
    v_add_f32 v21, v21, v5
    v_fmac_f32 v22, v4, v4
    v_fmac_f32 v23, v5, v5
    v_lshlrev_b32 v4, 16, v184
    v_and_b32 v5, s47, v184
    v_add_f32 v16, v16, v4
    v_add_f32 v17, v17, v5
    v_fmac_f32 v18, v4, v4
    v_fmac_f32 v19, v5, v5
    v_lshlrev_b32 v4, 16, v185
    v_and_b32 v5, s47, v185
    v_add_f32 v16, v16, v4
    v_add_f32 v17, v17, v5
    v_fmac_f32 v18, v4, v4
    v_fmac_f32 v19, v5, v5
    v_lshlrev_b32 v4, 16, v186
    v_and_b32 v5, s47, v186
    v_add_f32 v16, v16, v4
    v_add_f32 v17, v17, v5
    v_fmac_f32 v18, v4, v4
    v_fmac_f32 v19, v5, v5
    v_lshlrev_b32 v4, 16, v187
    v_and_b32 v5, s47, v187
    v_add_f32 v16, v16, v4
    v_add_f32 v17, v17, v5
    v_fmac_f32 v18, v4, v4
    v_fmac_f32 v19, v5, v5
    v_lshlrev_b32 v4, 16, v188
    v_and_b32 v5, s47, v188
    v_add_f32 v20, v20, v4
    v_add_f32 v21, v21, v5
    v_fmac_f32 v22, v4, v4
    v_fmac_f32 v23, v5, v5
    v_lshlrev_b32 v4, 16, v189
    v_and_b32 v5, s47, v189
    v_add_f32 v20, v20, v4
    v_add_f32 v21, v21, v5
    v_fmac_f32 v22, v4, v4
    v_fmac_f32 v23, v5, v5
    v_lshlrev_b32 v4, 16, v190
    v_and_b32 v5, s47, v190
    v_add_f32 v20, v20, v4
    v_add_f32 v21, v21, v5
    v_fmac_f32 v22, v4, v4
    v_fmac_f32 v23, v5, v5
    v_lshlrev_b32 v4, 16, v191
    v_and_b32 v5, s47, v191
    v_add_f32 v20, v20, v4
    v_add_f32 v21, v21, v5
    v_fmac_f32 v22, v4, v4
    v_fmac_f32 v23, v5, v5
    v_lshlrev_b32 v4, 16, v192
    v_and_b32 v5, s47, v192
    v_add_f32 v16, v16, v4
    v_add_f32 v17, v17, v5
    v_fmac_f32 v18, v4, v4
    v_fmac_f32 v19, v5, v5
    v_lshlrev_b32 v4, 16, v193
    v_and_b32 v5, s47, v193
    v_add_f32 v16, v16, v4
    v_add_f32 v17, v17, v5
    v_fmac_f32 v18, v4, v4
    v_fmac_f32 v19, v5, v5
    v_lshlrev_b32 v4, 16, v194
    v_and_b32 v5, s47, v194
    v_add_f32 v16, v16, v4
    v_add_f32 v17, v17, v5
    v_fmac_f32 v18, v4, v4
    v_fmac_f32 v19, v5, v5
    v_lshlrev_b32 v4, 16, v195
    v_and_b32 v5, s47, v195
    v_add_f32 v16, v16, v4
    v_add_f32 v17, v17, v5
    v_fmac_f32 v18, v4, v4
    v_fmac_f32 v19, v5, v5
    v_lshlrev_b32 v4, 16, v196
    v_and_b32 v5, s47, v196
    v_add_f32 v20, v20, v4
    v_add_f32 v21, v21, v5
    v_fmac_f32 v22, v4, v4
    v_fmac_f32 v23, v5, v5
    v_lshlrev_b32 v4, 16, v197
    v_and_b32 v5, s47, v197
    v_add_f32 v20, v20, v4
    v_add_f32 v21, v21, v5
    v_fmac_f32 v22, v4, v4
    v_fmac_f32 v23, v5, v5
    v_lshlrev_b32 v4, 16, v198
    v_and_b32 v5, s47, v198
    v_add_f32 v20, v20, v4
    v_add_f32 v21, v21, v5
    v_fmac_f32 v22, v4, v4
    v_fmac_f32 v23, v5, v5
    v_lshlrev_b32 v4, 16, v199
    v_and_b32 v5, s47, v199
    v_add_f32 v20, v20, v4
    v_add_f32 v21, v21, v5
    v_fmac_f32 v22, v4, v4
    v_fmac_f32 v23, v5, v5
    v_lshlrev_b32 v4, 16, v200
    v_and_b32 v5, s47, v200
    v_add_f32 v16, v16, v4
    v_add_f32 v17, v17, v5
    v_fmac_f32 v18, v4, v4
    v_fmac_f32 v19, v5, v5
    v_lshlrev_b32 v4, 16, v201
    v_and_b32 v5, s47, v201
    v_add_f32 v16, v16, v4
    v_add_f32 v17, v17, v5
    v_fmac_f32 v18, v4, v4
    v_fmac_f32 v19, v5, v5
    v_lshlrev_b32 v4, 16, v202
    v_and_b32 v5, s47, v202
    v_add_f32 v16, v16, v4
    v_add_f32 v17, v17, v5
    v_fmac_f32 v18, v4, v4
    v_fmac_f32 v19, v5, v5
    v_lshlrev_b32 v4, 16, v203
    v_and_b32 v5, s47, v203
    v_add_f32 v16, v16, v4
    v_add_f32 v17, v17, v5
    v_fmac_f32 v18, v4, v4
    v_fmac_f32 v19, v5, v5
    v_lshlrev_b32 v4, 16, v204
    v_and_b32 v5, s47, v204
    v_add_f32 v20, v20, v4
    v_add_f32 v21, v21, v5
    v_fmac_f32 v22, v4, v4
    v_fmac_f32 v23, v5, v5
    v_lshlrev_b32 v4, 16, v205
    v_and_b32 v5, s47, v205
    v_add_f32 v20, v20, v4
    v_add_f32 v21, v21, v5
    v_fmac_f32 v22, v4, v4
    v_fmac_f32 v23, v5, v5
    v_lshlrev_b32 v4, 16, v206
    v_and_b32 v5, s47, v206
    v_add_f32 v20, v20, v4
    v_add_f32 v21, v21, v5
    v_fmac_f32 v22, v4, v4
    v_fmac_f32 v23, v5, v5
    v_lshlrev_b32 v4, 16, v207
    v_and_b32 v5, s47, v207
    v_add_f32 v20, v20, v4
    v_add_f32 v21, v21, v5
    v_fmac_f32 v22, v4, v4
    v_fmac_f32 v23, v5, v5
    v_lshlrev_b32 v4, 16, v208
    v_and_b32 v5, s47, v208
    v_add_f32 v16, v16, v4
    v_add_f32 v17, v17, v5
    v_fmac_f32 v18, v4, v4
    v_fmac_f32 v19, v5, v5
    v_lshlrev_b32 v4, 16, v209
    v_and_b32 v5, s47, v209
    v_add_f32 v16, v16, v4
    v_add_f32 v17, v17, v5
    v_fmac_f32 v18, v4, v4
    v_fmac_f32 v19, v5, v5
    v_lshlrev_b32 v4, 16, v210
    v_and_b32 v5, s47, v210
    v_add_f32 v16, v16, v4
    v_add_f32 v17, v17, v5
    v_fmac_f32 v18, v4, v4
    v_fmac_f32 v19, v5, v5
    v_lshlrev_b32 v4, 16, v211
    v_and_b32 v5, s47, v211
    v_add_f32 v16, v16, v4
    v_add_f32 v17, v17, v5
    v_fmac_f32 v18, v4, v4
    v_fmac_f32 v19, v5, v5
    v_lshlrev_b32 v4, 16, v212
    v_and_b32 v5, s47, v212
    v_add_f32 v20, v20, v4
    v_add_f32 v21, v21, v5
    v_fmac_f32 v22, v4, v4
    v_fmac_f32 v23, v5, v5
    v_lshlrev_b32 v4, 16, v213
    v_and_b32 v5, s47, v213
    v_add_f32 v20, v20, v4
    v_add_f32 v21, v21, v5
    v_fmac_f32 v22, v4, v4
    v_fmac_f32 v23, v5, v5
    v_lshlrev_b32 v4, 16, v214
    v_and_b32 v5, s47, v214
    v_add_f32 v20, v20, v4
    v_add_f32 v21, v21, v5
    v_fmac_f32 v22, v4, v4
    v_fmac_f32 v23, v5, v5
    v_lshlrev_b32 v4, 16, v215
    v_and_b32 v5, s47, v215
    v_add_f32 v20, v20, v4
    v_add_f32 v21, v21, v5
    v_fmac_f32 v22, v4, v4
    v_fmac_f32 v23, v5, v5
    v_lshlrev_b32 v4, 16, v216
    v_and_b32 v5, s47, v216
    v_add_f32 v16, v16, v4
    v_add_f32 v17, v17, v5
    v_fmac_f32 v18, v4, v4
    v_fmac_f32 v19, v5, v5
    v_lshlrev_b32 v4, 16, v217
    v_and_b32 v5, s47, v217
    v_add_f32 v16, v16, v4
    v_add_f32 v17, v17, v5
    v_fmac_f32 v18, v4, v4
    v_fmac_f32 v19, v5, v5
    v_lshlrev_b32 v4, 16, v218
    v_and_b32 v5, s47, v218
    v_add_f32 v16, v16, v4
    v_add_f32 v17, v17, v5
    v_fmac_f32 v18, v4, v4
    v_fmac_f32 v19, v5, v5
    v_lshlrev_b32 v4, 16, v219
    v_and_b32 v5, s47, v219
    v_add_f32 v16, v16, v4
    v_add_f32 v17, v17, v5
    v_fmac_f32 v18, v4, v4
    v_fmac_f32 v19, v5, v5
    v_lshlrev_b32 v4, 16, v220
    v_and_b32 v5, s47, v220
    v_add_f32 v20, v20, v4
    v_add_f32 v21, v21, v5
    v_fmac_f32 v22, v4, v4
    v_fmac_f32 v23, v5, v5
    v_lshlrev_b32 v4, 16, v221
    v_and_b32 v5, s47, v221
    v_add_f32 v20, v20, v4
    v_add_f32 v21, v21, v5
    v_fmac_f32 v22, v4, v4
    v_fmac_f32 v23, v5, v5
    v_lshlrev_b32 v4, 16, v222
    v_and_b32 v5, s47, v222
    v_add_f32 v20, v20, v4
    v_add_f32 v21, v21, v5
    v_fmac_f32 v22, v4, v4
    v_fmac_f32 v23, v5, v5
    v_lshlrev_b32 v4, 16, v223
    v_and_b32 v5, s47, v223
    v_add_f32 v20, v20, v4
    v_add_f32 v21, v21, v5
    v_fmac_f32 v22, v4, v4
    v_fmac_f32 v23, v5, v5
    v_lshlrev_b32 v4, 16, v224
    v_and_b32 v5, s47, v224
    v_add_f32 v16, v16, v4
    v_add_f32 v17, v17, v5
    v_fmac_f32 v18, v4, v4
    v_fmac_f32 v19, v5, v5
    v_lshlrev_b32 v4, 16, v225
    v_and_b32 v5, s47, v225
    v_add_f32 v16, v16, v4
    v_add_f32 v17, v17, v5
    v_fmac_f32 v18, v4, v4
    v_fmac_f32 v19, v5, v5
    v_lshlrev_b32 v4, 16, v226
    v_and_b32 v5, s47, v226
    v_add_f32 v16, v16, v4
    v_add_f32 v17, v17, v5
    v_fmac_f32 v18, v4, v4
    v_fmac_f32 v19, v5, v5
    v_lshlrev_b32 v4, 16, v227
    v_and_b32 v5, s47, v227
    v_add_f32 v16, v16, v4
    v_add_f32 v17, v17, v5
    v_fmac_f32 v18, v4, v4
    v_fmac_f32 v19, v5, v5
    v_lshlrev_b32 v4, 16, v228
    v_and_b32 v5, s47, v228
    v_add_f32 v20, v20, v4
    v_add_f32 v21, v21, v5
    v_fmac_f32 v22, v4, v4
    v_fmac_f32 v23, v5, v5
    v_lshlrev_b32 v4, 16, v229
    v_and_b32 v5, s47, v229
    v_add_f32 v20, v20, v4
    v_add_f32 v21, v21, v5
    v_fmac_f32 v22, v4, v4
    v_fmac_f32 v23, v5, v5
    v_lshlrev_b32 v4, 16, v230
    v_and_b32 v5, s47, v230
    v_add_f32 v20, v20, v4
    v_add_f32 v21, v21, v5
    v_fmac_f32 v22, v4, v4
    v_fmac_f32 v23, v5, v5
    v_lshlrev_b32 v4, 16, v231
    v_and_b32 v5, s47, v231
    v_add_f32 v20, v20, v4
    v_add_f32 v21, v21, v5
    v_fmac_f32 v22, v4, v4
    v_fmac_f32 v23, v5, v5
    v_lshlrev_b32 v4, 16, v232
    v_and_b32 v5, s47, v232
    v_add_f32 v16, v16, v4
    v_add_f32 v17, v17, v5
    v_fmac_f32 v18, v4, v4
    v_fmac_f32 v19, v5, v5
    v_lshlrev_b32 v4, 16, v233
    v_and_b32 v5, s47, v233
    v_add_f32 v16, v16, v4
    v_add_f32 v17, v17, v5
    v_fmac_f32 v18, v4, v4
    v_fmac_f32 v19, v5, v5
    v_lshlrev_b32 v4, 16, v234
    v_and_b32 v5, s47, v234
    v_add_f32 v16, v16, v4
    v_add_f32 v17, v17, v5
    v_fmac_f32 v18, v4, v4
    v_fmac_f32 v19, v5, v5
    v_lshlrev_b32 v4, 16, v235
    v_and_b32 v5, s47, v235
    v_add_f32 v16, v16, v4
    v_add_f32 v17, v17, v5
    v_fmac_f32 v18, v4, v4
    v_fmac_f32 v19, v5, v5
    v_lshlrev_b32 v4, 16, v236
    v_and_b32 v5, s47, v236
    v_add_f32 v20, v20, v4
    v_add_f32 v21, v21, v5
    v_fmac_f32 v22, v4, v4
    v_fmac_f32 v23, v5, v5
    v_lshlrev_b32 v4, 16, v237
    v_and_b32 v5, s47, v237
    v_add_f32 v20, v20, v4
    v_add_f32 v21, v21, v5
    v_fmac_f32 v22, v4, v4
    v_fmac_f32 v23, v5, v5
    v_lshlrev_b32 v4, 16, v238
    v_and_b32 v5, s47, v238
    v_add_f32 v20, v20, v4
    v_add_f32 v21, v21, v5
    v_fmac_f32 v22, v4, v4
    v_fmac_f32 v23, v5, v5
    v_lshlrev_b32 v4, 16, v239
    v_and_b32 v5, s47, v239
    v_add_f32 v20, v20, v4
    v_add_f32 v21, v21, v5
    v_fmac_f32 v22, v4, v4
    v_fmac_f32 v23, v5, v5
    v_lshlrev_b32 v4, 16, v240
    v_and_b32 v5, s47, v240
    v_add_f32 v16, v16, v4
    v_add_f32 v17, v17, v5
    v_fmac_f32 v18, v4, v4
    v_fmac_f32 v19, v5, v5
    v_lshlrev_b32 v4, 16, v241
    v_and_b32 v5, s47, v241
    v_add_f32 v16, v16, v4
    v_add_f32 v17, v17, v5
    v_fmac_f32 v18, v4, v4
    v_fmac_f32 v19, v5, v5
    v_lshlrev_b32 v4, 16, v242
    v_and_b32 v5, s47, v242
    v_add_f32 v16, v16, v4
    v_add_f32 v17, v17, v5
    v_fmac_f32 v18, v4, v4
    v_fmac_f32 v19, v5, v5
    v_lshlrev_b32 v4, 16, v243
    v_and_b32 v5, s47, v243
    v_add_f32 v16, v16, v4
    v_add_f32 v17, v17, v5
    v_fmac_f32 v18, v4, v4
    v_fmac_f32 v19, v5, v5
    v_lshlrev_b32 v4, 16, v244
    v_and_b32 v5, s47, v244
    v_add_f32 v20, v20, v4
    v_add_f32 v21, v21, v5
    v_fmac_f32 v22, v4, v4
    v_fmac_f32 v23, v5, v5
    v_lshlrev_b32 v4, 16, v245
    v_and_b32 v5, s47, v245
    v_add_f32 v20, v20, v4
    v_add_f32 v21, v21, v5
    v_fmac_f32 v22, v4, v4
    v_fmac_f32 v23, v5, v5
    v_lshlrev_b32 v4, 16, v246
    v_and_b32 v5, s47, v246
    v_add_f32 v20, v20, v4
    v_add_f32 v21, v21, v5
    v_fmac_f32 v22, v4, v4
    v_fmac_f32 v23, v5, v5
    v_lshlrev_b32 v4, 16, v247
    v_and_b32 v5, s47, v247
    v_add_f32 v20, v20, v4
    v_add_f32 v21, v21, v5
    v_fmac_f32 v22, v4, v4
    v_fmac_f32 v23, v5, v5
    v_lshlrev_b32 v4, 16, v248
    v_and_b32 v5, s47, v248
    v_add_f32 v16, v16, v4
    v_add_f32 v17, v17, v5
    v_fmac_f32 v18, v4, v4
    v_fmac_f32 v19, v5, v5
    v_lshlrev_b32 v4, 16, v249
    v_and_b32 v5, s47, v249
    v_add_f32 v16, v16, v4
    v_add_f32 v17, v17, v5
    v_fmac_f32 v18, v4, v4
    v_fmac_f32 v19, v5, v5
    v_lshlrev_b32 v4, 16, v250
    v_and_b32 v5, s47, v250
    v_add_f32 v16, v16, v4
    v_add_f32 v17, v17, v5
    v_fmac_f32 v18, v4, v4
    v_fmac_f32 v19, v5, v5
    v_lshlrev_b32 v4, 16, v251
    v_and_b32 v5, s47, v251
    v_add_f32 v16, v16, v4
    v_add_f32 v17, v17, v5
    v_fmac_f32 v18, v4, v4
    v_fmac_f32 v19, v5, v5
    v_lshlrev_b32 v4, 16, v252
    v_and_b32 v5, s47, v252
    v_add_f32 v20, v20, v4
    v_add_f32 v21, v21, v5
    v_fmac_f32 v22, v4, v4
    v_fmac_f32 v23, v5, v5
    v_lshlrev_b32 v4, 16, v253
    v_and_b32 v5, s47, v253
    v_add_f32 v20, v20, v4
    v_add_f32 v21, v21, v5
    v_fmac_f32 v22, v4, v4
    v_fmac_f32 v23, v5, v5
    v_lshlrev_b32 v4, 16, v254
    v_and_b32 v5, s47, v254
    v_add_f32 v20, v20, v4
    v_add_f32 v21, v21, v5
    v_fmac_f32 v22, v4, v4
    v_fmac_f32 v23, v5, v5
    v_lshlrev_b32 v4, 16, v255
    v_and_b32 v5, s47, v255
    v_add_f32 v20, v20, v4
    v_add_f32 v21, v21, v5
    v_fmac_f32 v22, v4, v4
    v_fmac_f32 v23, v5, v5
    v_add_f32 v16, v16, v17
    v_add_f32 v18, v18, v19
    v_add_f32 v20, v20, v21
    v_add_f32 v22, v22, v23
    v_mov_b32 v17, v16
    v_mov_b32 v19, v18
    v_mov_b32 v21, v20
    v_mov_b32 v23, v22
    s_nop 1
    v_permlane32_swap_b32 v16, v17
    v_permlane32_swap_b32 v18, v19
    v_permlane32_swap_b32 v20, v21
    v_permlane32_swap_b32 v22, v23
    v_add_f32 v16, v16, v17
    v_add_f32 v18, v18, v19
    v_add_f32 v20, v20, v21
    v_add_f32 v22, v22, v23
    v_mov_b32 v17, v16
    v_mov_b32 v19, v18
    v_mov_b32 v21, v20
    v_mov_b32 v23, v22
    s_nop 1
    v_permlane16_swap_b32 v16, v17
    v_permlane16_swap_b32 v18, v19
    v_permlane16_swap_b32 v20, v21
    v_permlane16_swap_b32 v22, v23
    v_add_f32 v16, v16, v17
    v_add_f32 v18, v18, v19
    v_add_f32 v20, v20, v21
    v_add_f32 v22, v22, v23
    v_mul_f32 v16, s44, v16
    v_mul_f32 v17, s44, v18
    v_fma_f32 v17, -v16, v16, v17
    v_max_f32 v17, 0, v17
    v_add_f32 v17, 0x3727c5ac, v17
    v_mul_f32 v20, s44, v20
    v_mul_f32 v21, s44, v22
    v_fma_f32 v21, -v20, v20, v21
    v_max_f32 v21, 0, v21
    v_add_f32 v21, 0x3727c5ac, v21
    s_branch kc_statok
kc_spin_16:
    s_mov_b32 s67, 0
kc_sl_36:
    buffer_load_dword v13, v12, s[60:63], 0 offen sc1
    s_add_u32 s67, s67, 1
    s_waitcnt vmcnt(0)
    v_cmp_gt_u32 vcc, 4, v13
    s_cmp_ge_u32 s67, 0x8000
    s_cbranch_scc1 kc_fok_15
    s_cbranch_vccnz kc_sl_36
    s_branch kc_fok_15

kc_spin_22:
    s_mov_b32 s67, 0
kc_sl_37:
    buffer_load_dword v13, v12, s[60:63], 0 offen sc1
    s_add_u32 s67, s67, 1
    s_waitcnt vmcnt(0)
    v_cmp_gt_u32 vcc, 6, v13
    s_cmp_ge_u32 s67, 0x8000
    s_cbranch_scc1 kc_fok_21
    s_cbranch_vccnz kc_sl_37
    s_branch kc_fok_21

kc_spin_29:
    s_mov_b32 s67, 0
kc_sl_38:
    buffer_load_dword v13, v12, s[60:63], 0 offen sc1
    s_add_u32 s67, s67, 1
    s_waitcnt vmcnt(0)
    v_cmp_gt_u32 vcc, 9, v13
    s_cmp_ge_u32 s67, 0x8000
    s_cbranch_scc1 kc_fok_28
    s_cbranch_vccnz kc_sl_38
    s_branch kc_fok_28

code_end:
    s_endpgm
.section .rodata,"a"
.p2align 6
.amdhsa_kernel ka_kernel
  .amdhsa_next_free_vgpr 176
  .amdhsa_next_free_sgpr 72
  .amdhsa_accum_offset 176
  .amdhsa_group_segment_fixed_size 0
  .amdhsa_kernarg_size 104
  .amdhsa_user_sgpr_count 2
  .amdhsa_user_sgpr_kernarg_segment_ptr 1
  .amdhsa_system_sgpr_workgroup_id_x 1
.end_amdhsa_kernel
.p2align 6
.amdhsa_kernel kc_kernel
  .amdhsa_next_free_vgpr 256
  .amdhsa_next_free_sgpr 72
  .amdhsa_accum_offset 256
  .amdhsa_group_segment_fixed_size 0
  .amdhsa_kernarg_size 104
  .amdhsa_user_sgpr_count 2
  .amdhsa_user_sgpr_kernarg_segment_ptr 1
  .amdhsa_system_sgpr_workgroup_id_x 1
.end_amdhsa_kernel
```
